```python
import torch

def _softmax(x, axis=-1):
    return torch.softmax(x, dim=axis)
def _gelu(x):
    return torch.nn.functional.gelu(x, approximate="tanh")
def _silu(x):
    return torch.nn.functional.silu(x)
def _sigmoid(x):
    return torch.sigmoid(x)
def _layernorm(x, axis=-1, eps=1e-5):
    m = x.mean(dim=axis, keepdim=True)
    v = x.var(dim=axis, keepdim=True, unbiased=False)
    return (x - m) / torch.sqrt(v + eps)
def _scatter_add(tgt, idx, src, axis=0):
    return tgt.clone().index_add_(axis, idx, src)
def _segment_sum(src, seg, n):
    out = torch.zeros((n,) + src.shape[1:], dtype=src.dtype)
    return out.index_add_(0, seg, src)
def _pad(x, pw):
    flat = tuple(v for pair in reversed(pw) for v in pair)
    return torch.nn.functional.pad(x, flat)

kernel_name = 'parallel_sum__ssm_conv_s5__dense_activation_mish__prompt'

def setup_inputs():

    _w = (lambda a: (lambda t: t.to(torch.bfloat16) if t.is_floating_point() else t)(torch.as_tensor(a)))
    def _A_setup():
        B, S, D = 1, 2048, 640
        P = D
        Lambda_re = -0.5 * (lambda _x: torch.exp(torch.as_tensor(_x)))((lambda *s: torch.randn(*s, dtype=torch.bfloat16) * 0.2)(P))
        Lambda_im = (lambda *s: torch.randn(*s, dtype=torch.bfloat16) * 0.8)(P) * 1.0
        B_re = (lambda *s: torch.randn(*s, dtype=torch.bfloat16) * 0.2)(P, D) * (D ** -0.5)
        B_im = (lambda *s: torch.randn(*s, dtype=torch.bfloat16) * 0.2)(P, D) * (D ** -0.5)
        C_re = (lambda *s: torch.randn(*s, dtype=torch.bfloat16) * 0.2)(D, P) * (P ** -0.5)
        C_im = (lambda *s: torch.randn(*s, dtype=torch.bfloat16) * 0.2)(D, P) * (P ** -0.5)
        log_dt = (lambda *s: torch.randn(*s, dtype=torch.bfloat16) * 0.2)(P) * 0.3 - 2.0
        Dskip = (lambda *s: torch.randn(*s, dtype=torch.bfloat16) * 0.05)(D)
        return {
            "x": _w((lambda *s: torch.randn(*s, dtype=torch.bfloat16) * 0.05)(B, S, D)),
            "Lambda_re": _w(Lambda_re),
            "Lambda_im": _w(Lambda_im),
            "B_re": _w(B_re),
            "B_im": _w(B_im),
            "C_re": _w(C_re),
            "C_im": _w(C_im),
            "log_dt": _w(log_dt),
            "Dskip": _w(Dskip),
        }
    _A_in = _A_setup()

    def _B_setup():
        B, S, D, F = 1, 2048, 640, 1728
        return {
            "x": _w((lambda *s: torch.randn(*s, dtype=torch.bfloat16) * 0.05)(B, S, D)),
            "w1": _w((lambda *s: torch.randn(*s, dtype=torch.bfloat16) * 0.8)(D, F) * (D ** -0.5)),
            "b1": _w((lambda *s: torch.randn(*s, dtype=torch.bfloat16) * 0.2)(F)),
            "w2": _w((lambda *s: torch.randn(*s, dtype=torch.bfloat16) * 0.2)(F, D) * (F ** -0.5)),
        }
    _B_in = _B_setup()

    return {
        "A_x": _A_in["x"],
        "A_Lambda_re": _A_in["Lambda_re"],
        "A_Lambda_im": _A_in["Lambda_im"],
        "A_B_re": _A_in["B_re"],
        "A_B_im": _A_in["B_im"],
        "A_C_re": _A_in["C_re"],
        "A_C_im": _A_in["C_im"],
        "A_log_dt": _A_in["log_dt"],
        "A_Dskip": _A_in["Dskip"],
        "B_x": _B_in["x"],
        "B_w1": _B_in["w1"],
        "B_b1": _B_in["b1"],
        "B_w2": _B_in["w2"],
    }

def reference(A_x, A_Lambda_re, A_Lambda_im, A_B_re, A_B_im, A_C_re, A_C_im, A_log_dt, A_Dskip, B_x, B_w1, B_b1, B_w2):
    def _A_ref(x, Lambda_re, Lambda_im, B_re, B_im, C_re, C_im, log_dt, Dskip):
        Bsz, L, H = x.shape
        Lam = Lambda_re + 1j * Lambda_im
        Bmat = B_re + 1j * B_im
        Cmat = C_re + 1j * C_im
        dt = torch.exp(log_dt)
        Lam_bar = torch.exp(dt * Lam)
        B_bar = ((Lam_bar - 1.0) / Lam)[:, None] * Bmat
        Bu = torch.einsum("bld,pd->blp", x + 0j, B_bar)
        h = torch.zeros_like(Bu[:, 0, :])
        hs = []
        for t in range(L):
            h = Lam_bar[None, :] * h + Bu[:, t, :]
            hs.append(h)
        hseq = torch.stack(hs, 1)
        y = 2.0 * torch.einsum("blp,dp->bld", hseq, Cmat).real + x * Dskip[None, None, :]
        return y

    def _B_ref(x, w1, b1, w2):
        h = torch.einsum("bsd,df->bsf", x, w1) + b1
        sp = torch.log1p(torch.exp(-torch.abs(h))) + torch.where(h > 0, h, torch.zeros_like(h))
        act = h * torch.tanh(sp)
        return torch.einsum("bsf,fd->bsd", act, w2)

    x = A_x
    xn = _layernorm(x, axis=-1)
    return x + _A_ref(xn, A_Lambda_re, A_Lambda_im, A_B_re, A_B_im, A_C_re, A_C_im, A_log_dt, A_Dskip) + _B_ref(xn, B_w1, B_b1, B_w2)
```

```asm
; @launch grid=(256,1,1) block=(512,1,1) lds=163840
.amdgcn_target "amdgcn-amd-amdhsa--gfx950"
.text
.globl parallel_sum__ssm_conv_s5__dense_activation_mish__prompt_kernel
.p2align 8
.type parallel_sum__ssm_conv_s5__dense_activation_mish__prompt_kernel,@function
parallel_sum__ssm_conv_s5__dense_activation_mish__prompt_kernel:
    s_cmp_ge_u32 s2, 256
    s_cbranch_scc1 K_done
    s_load_dwordx16 s[4:19], s[0:1], 0
    s_load_dwordx16 s[20:35], s[0:1], 64
    s_getpc_b64 s[90:91]
    s_lshr_b32 s72, s2, 3
    s_and_b32 s72, s72, 15
    s_mul_i32 s72, s72, 16
    v_add_u32 v1, s72, v0
    v_lshlrev_b32 v1, 7, v1
    v_min_u32 v1, K_end-parallel_sum__ssm_conv_s5__dense_activation_mish__prompt_kernel-256, v1
    v_cmp_gt_u32 vcc, 16, v0
    s_and_saveexec_b64 s[88:89], vcc
    s_cbranch_execz K_npf
    global_load_dword v255, v1, s[90:91]
K_npf:
    s_mov_b64 exec, -1
    v_lshrrev_b32 v1, 6, v0
    v_and_b32 v2, 63, v0
    s_and_b32 s72, s2, 7
    s_lshr_b32 s73, s2, 3
    v_readfirstlane_b32 s38, v1
    s_lshr_b32 s75, s72, 1
    s_and_b32 s96, s72, 1
    s_lshl_b32 s36, s75, 2
    s_and_b32 s74, s73, 3
    s_add_u32 s36, s36, s74
    s_lshr_b32 s97, s73, 2
    s_lshl_b32 s37, s96, 3
    s_add_u32 s37, s37, s97
    s_sub_u32 s74, s37, 9
    s_cmp_ge_u32 s37, 9
    s_cselect_b32 s40, s74, s37
    s_cselect_b32 s39, 1, 0
    s_cselect_b64 s[86:87], -1, 0
    s_mul_i32 s41, s75, 5
    s_add_u32 s41, s41, 1
    s_lshr_b32 s41, s41, 1
    s_mul_i32 s74, s96, 5
    s_add_u32 s41, s41, s74
    s_lshr_b32 s76, s97, 2
    s_mul_i32 s74, s76, 3
    s_add_u32 s41, s41, s74
    s_sub_u32 s74, s41, 10
    s_cmp_lt_u32 s41, 10
    s_cselect_b32 s41, s41, s74
    s_lshr_b32 s43, s38, 2
    s_lshr_b32 s42, s38, 1
    s_and_b32 s38, s38, 3
    v_lshlrev_b32 v7, 4, v2
    s_cmp_lg_u32 s42, 2
    s_cbranch_scc1 K_notloader
    s_setprio 3
    v_lshrrev_b32 v8, 3, v2
    v_and_b32 v9, 7, v2
    s_lshl_b32 s80, s38, 4
    v_add_u32 v10, s80, v8
    v_bfe_u32 v11, v10, 1, 3
    v_xor_b32 v11, v11, v9
    v_lshlrev_b32 v11, 4, v11
    v_bfe_u32 v12, v10, 2, 1
    v_lshlrev_b32 v12, 4, v12
    v_and_b32 v13, 1, v10
    v_lshl_add_u32 v12, v13, 3, v12
    v_bfe_u32 v13, v10, 3, 2
    v_lshl_add_u32 v12, v13, 1, v12
    v_bfe_u32 v13, v10, 1, 1
    v_add_u32 v12, v13, v12
    v_cndmask_b32 v12, v10, v12, s[86:87]
    s_lshl_b32 s80, s36, 7
    v_add_u32 v12, s80, v12
    v_mul_u32_u24 v12, 1280, v12
    v_xor_b32 v16, 64, v11
    v_add_u32 v14, v12, v16
    v_add_u32 v12, v12, v11
    s_cmp_eq_u32 s39, 1
    s_mov_b32 s80, 10240
    s_cmov_b32 s80, 2560
    v_add_u32 v14, s80, v14
    s_lshl_b32 s81, s38, 11
    s_mov_b32 s83, s41
    s_waitcnt lgkmcnt(0)
    s_mov_b32 s44, s4
    s_mov_b32 s45, s5
    s_mov_b32 s46, 2621440
    s_mov_b32 s47, 0x20000
    s_lshl_b32 s84, s83, 7
    s_add_u32 m0, s81, 0
    s_nop 0
    buffer_load_dwordx4 v12, s[44:47], s84 offen  lds
    s_add_u32 m0, m0, 1024
    s_nop 0
    buffer_load_dwordx4 v14, s[44:47], s84 offen  lds
    s_add_u32 m0, s81, 4096
    s_add_u32 s84, s84, 40960
    buffer_load_dwordx4 v12, s[44:47], s84 offen  lds
    s_add_u32 m0, m0, 1024
    s_nop 0
    buffer_load_dwordx4 v14, s[44:47], s84 offen  lds
    s_add_u32 m0, s81, 8192
    s_add_u32 s84, s84, 40960
    buffer_load_dwordx4 v12, s[44:47], s84 offen  lds
    s_add_u32 m0, m0, 1024
    s_nop 0
    buffer_load_dwordx4 v14, s[44:47], s84 offen  lds
    s_add_u32 m0, s81, 12288
    s_add_u32 s84, s84, 40960
    buffer_load_dwordx4 v12, s[44:47], s84 offen  lds
    s_add_u32 m0, m0, 1024
    s_nop 0
    buffer_load_dwordx4 v14, s[44:47], s84 offen  lds
    s_cmp_eq_u32 s39, 1
    s_cselect_b32 s48, s10, s24
    s_cselect_b32 s49, s11, s25
    s_cselect_b32 s52, s12, s24
    s_cselect_b32 s53, s13, s25
    s_mov_b32 s50, 2211840
    s_cmov_b32 s50, 819200
    s_mov_b32 s54, s50
    s_mov_b32 s51, 0x20000
    s_mov_b32 s55, 0x20000
    s_mov_b32 s75, 221184
    s_cmov_b32 s75, 128
    s_mov_b32 s76, 128
    s_cmov_b32 s76, 40960
    s_cselect_b32 s77, 0, 27648
    s_mov_b32 s78, 1024
    s_cmov_b32 s78, 4096
    s_mov_b32 s79, 2048
    s_cmov_b32 s79, 1024
    s_mul_i32 s80, s40, 96
    v_add_u32 v13, s80, v10
    v_mul_u32_u24 v13, 1280, v13
    v_add_u32 v15, v13, v16
    v_add_u32 v15, 10240, v15
    v_add_u32 v13, v13, v11
    v_bfe_u32 v17, v8, 1, 1
    v_lshlrev_b32 v17, 2, v17
    v_xor_b32 v17, v17, v9
    v_lshlrev_b32 v17, 4, v17
    s_lshl_b32 s80, s38, 5
    v_add_u32 v18, s80, v8
    v_mul_u32_u24 v18, 3456, v18
    v_add_u32 v18, v18, v17
    s_mul_i32 s80, s40, 384
    v_add_u32 v18, s80, v18
    v_add_u32 v19, 55296, v18
    v_cndmask_b32 v13, v18, v13, s[86:87]
    v_cndmask_b32 v15, v19, v15, s[86:87]
    s_mul_i32 s82, s38, s79
    s_lshl_b32 s82, s82, 1
    s_add_u32 s82, s82, 16384
    s_mul_i32 s85, s83, s75
    s_add_u32 m0, s82, 0
    s_nop 0
    buffer_load_dwordx4 v13, s[48:51], s85 offen  lds
    s_add_u32 m0, m0, s79
    s_add_u32 s80, s85, s77
    buffer_load_dwordx4 v15, s[48:51], s85 offen  lds
    s_add_u32 m0, m0, s78
    s_nop 0
    buffer_load_dwordx4 v15, s[52:55], s80 offen  lds
    s_sub_u32 m0, m0, s79
    s_nop 0
    buffer_load_dwordx4 v13, s[52:55], s80 offen  lds
    s_add_u32 m0, s82, 8192
    s_add_u32 s85, s85, s76
    buffer_load_dwordx4 v13, s[48:51], s85 offen  lds
    s_add_u32 m0, m0, s79
    s_add_u32 s80, s85, s77
    buffer_load_dwordx4 v15, s[48:51], s85 offen  lds
    s_add_u32 m0, m0, s78
    s_nop 0
    buffer_load_dwordx4 v15, s[52:55], s80 offen  lds
    s_sub_u32 m0, m0, s79
    s_nop 0
    buffer_load_dwordx4 v13, s[52:55], s80 offen  lds
    s_add_u32 m0, s82, 16384
    s_add_u32 s85, s85, s76
    buffer_load_dwordx4 v13, s[48:51], s85 offen  lds
    s_add_u32 m0, m0, s79
    s_add_u32 s80, s85, s77
    buffer_load_dwordx4 v15, s[48:51], s85 offen  lds
    s_add_u32 m0, m0, s78
    s_nop 0
    buffer_load_dwordx4 v15, s[52:55], s80 offen  lds
    s_sub_u32 m0, m0, s79
    s_nop 0
    buffer_load_dwordx4 v13, s[52:55], s80 offen  lds
    s_add_u32 s83, s83, 1
    s_cmp_eq_u32 s83, 10
    s_cselect_b32 s83, 0, s83
    s_lshl_b32 s84, s83, 7
    s_add_u32 m0, s81, 40960
    s_nop 0
    buffer_load_dwordx4 v12, s[44:47], s84 offen  lds
    s_add_u32 m0, m0, 1024
    s_nop 0
    buffer_load_dwordx4 v14, s[44:47], s84 offen  lds
    s_add_u32 m0, s81, 45056
    s_add_u32 s84, s84, 40960
    buffer_load_dwordx4 v12, s[44:47], s84 offen  lds
    s_add_u32 m0, m0, 1024
    s_nop 0
    buffer_load_dwordx4 v14, s[44:47], s84 offen  lds
    s_add_u32 m0, s81, 49152
    s_add_u32 s84, s84, 40960
    buffer_load_dwordx4 v12, s[44:47], s84 offen  lds
    s_add_u32 m0, m0, 1024
    s_nop 0
    buffer_load_dwordx4 v14, s[44:47], s84 offen  lds
    s_add_u32 m0, s81, 53248
    s_add_u32 s84, s84, 40960
    buffer_load_dwordx4 v12, s[44:47], s84 offen  lds
    s_add_u32 m0, m0, 1024
    s_nop 0
    buffer_load_dwordx4 v14, s[44:47], s84 offen  lds
    s_mul_i32 s85, s83, s75
    s_add_u32 m0, s82, 40960
    s_nop 0
    buffer_load_dwordx4 v13, s[48:51], s85 offen  lds
    s_add_u32 m0, m0, s79
    s_add_u32 s80, s85, s77
    buffer_load_dwordx4 v15, s[48:51], s85 offen  lds
    s_add_u32 m0, m0, s78
    s_nop 0
    buffer_load_dwordx4 v15, s[52:55], s80 offen  lds
    s_sub_u32 m0, m0, s79
    s_nop 0
    buffer_load_dwordx4 v13, s[52:55], s80 offen  lds
    s_add_u32 m0, s82, 49152
    s_add_u32 s85, s85, s76
    buffer_load_dwordx4 v13, s[48:51], s85 offen  lds
    s_add_u32 m0, m0, s79
    s_add_u32 s80, s85, s77
    buffer_load_dwordx4 v15, s[48:51], s85 offen  lds
    s_add_u32 m0, m0, s78
    s_nop 0
    buffer_load_dwordx4 v15, s[52:55], s80 offen  lds
    s_sub_u32 m0, m0, s79
    s_nop 0
    buffer_load_dwordx4 v13, s[52:55], s80 offen  lds
    s_add_u32 m0, s82, 57344
    s_add_u32 s85, s85, s76
    buffer_load_dwordx4 v13, s[48:51], s85 offen  lds
    s_add_u32 m0, m0, s79
    s_add_u32 s80, s85, s77
    buffer_load_dwordx4 v15, s[48:51], s85 offen  lds
    s_add_u32 m0, m0, s78
    s_nop 0
    buffer_load_dwordx4 v15, s[52:55], s80 offen  lds
    s_sub_u32 m0, m0, s79
    s_nop 0
    buffer_load_dwordx4 v13, s[52:55], s80 offen  lds
    s_add_u32 s83, s83, 1
    s_cmp_eq_u32 s83, 10
    s_cselect_b32 s83, 0, s83
    s_mov_b32 s56, s34
    s_mov_b32 s57, s35
    s_mov_b32 s58, 268435456
    s_mov_b32 s59, 0x20000
    s_mov_b32 s22, s4
    s_mov_b32 s23, s5
    s_lshl_b32 s74, s36, 1
    s_lshr_b32 s16, s38, 1
    s_add_u32 s74, s74, s16
    s_mul_i32 s74, s74, 393216
    s_and_b32 s16, s38, 1
    s_lshl_b32 s16, s16, 11
    s_add_u32 s74, s74, s16
    s_mul_i32 s16, s96, 147456
    s_add_u32 s74, s74, s16
    s_add_u32 s4, s34, s74
    s_addc_u32 s5, s35, 0
    s_mov_b32 s6, 385024
    s_mov_b32 s7, 0x20000
    s_mul_i32 s74, s97, 491520
    s_add_u32 s74, s74, 12582912
    s_mul_i32 s16, s96, 184320
    s_add_u32 s74, s74, s16
    s_add_u32 s8, s34, s74
    s_addc_u32 s9, s35, 0
    s_mov_b32 s10, 481280
    s_mov_b32 s11, 0x20000
    s_cmp_eq_u32 s96, 1
    s_cmov_b32 s6, 196608
    s_cmov_b32 s10, 245760
    s_mov_b32 s12, s30
    s_mov_b32 s13, s31
    s_mov_b32 s14, 5242880
    s_mov_b32 s15, 0x20000
    s_mul_i32 s17, s38, 5120
    v_add_u32 v1, 4096, v7
    s_cmp_eq_u32 s96, 0
    s_cselect_b32 s101, 245760, 0
    s_add_u32 s101, s101, s17
    s_lshl_b32 s74, s36, 3
    s_add_u32 s74, s74, s97
    s_lshl_b32 s19, s74, 7
    s_add_u32 s19, s19, 17694720
    s_lshl_b32 s74, s74, 2
    s_add_u32 s74, s74, s38
    s_mul_i32 s18, s74, 10240
    s_add_u32 s18, s18, 17825792
    s_waitcnt vmcnt(20)
    s_barrier
    s_setprio 0
    s_lshl_b32 s84, s83, 7
    s_add_u32 m0, s81, 81920
    s_nop 0
    buffer_load_dwordx4 v12, s[44:47], s84 offen  lds
    s_add_u32 m0, m0, 1024
    s_nop 0
    buffer_load_dwordx4 v14, s[44:47], s84 offen  lds
    s_add_u32 m0, s81, 86016
    s_add_u32 s84, s84, 40960
    buffer_load_dwordx4 v12, s[44:47], s84 offen  lds
    s_add_u32 m0, m0, 1024
    s_nop 0
    buffer_load_dwordx4 v14, s[44:47], s84 offen  lds
    s_add_u32 m0, s81, 90112
    s_add_u32 s84, s84, 40960
    buffer_load_dwordx4 v12, s[44:47], s84 offen  lds
    s_add_u32 m0, m0, 1024
    s_nop 0
    buffer_load_dwordx4 v14, s[44:47], s84 offen  lds
    s_add_u32 m0, s81, 94208
    s_add_u32 s84, s84, 40960
    buffer_load_dwordx4 v12, s[44:47], s84 offen  lds
    s_add_u32 m0, m0, 1024
    s_nop 0
    buffer_load_dwordx4 v14, s[44:47], s84 offen  lds
    s_mul_i32 s85, s83, s75
    s_add_u32 m0, s82, 81920
    s_nop 0
    buffer_load_dwordx4 v13, s[48:51], s85 offen  lds
    s_add_u32 m0, m0, s79
    s_add_u32 s80, s85, s77
    buffer_load_dwordx4 v15, s[48:51], s85 offen  lds
    s_add_u32 m0, m0, s78
    s_nop 0
    buffer_load_dwordx4 v15, s[52:55], s80 offen  lds
    s_sub_u32 m0, m0, s79
    s_nop 0
    buffer_load_dwordx4 v13, s[52:55], s80 offen  lds
    s_add_u32 m0, s82, 90112
    s_add_u32 s85, s85, s76
    buffer_load_dwordx4 v13, s[48:51], s85 offen  lds
    s_add_u32 m0, m0, s79
    s_add_u32 s80, s85, s77
    buffer_load_dwordx4 v15, s[48:51], s85 offen  lds
    s_add_u32 m0, m0, s78
    s_nop 0
    buffer_load_dwordx4 v15, s[52:55], s80 offen  lds
    s_sub_u32 m0, m0, s79
    s_nop 0
    buffer_load_dwordx4 v13, s[52:55], s80 offen  lds
    s_add_u32 m0, s82, 98304
    s_add_u32 s85, s85, s76
    buffer_load_dwordx4 v13, s[48:51], s85 offen  lds
    s_add_u32 m0, m0, s79
    s_add_u32 s80, s85, s77
    buffer_load_dwordx4 v15, s[48:51], s85 offen  lds
    s_add_u32 m0, m0, s78
    s_nop 0
    buffer_load_dwordx4 v15, s[52:55], s80 offen  lds
    s_sub_u32 m0, m0, s79
    s_nop 0
    buffer_load_dwordx4 v13, s[52:55], s80 offen  lds
    s_add_u32 s83, s83, 1
    s_cmp_eq_u32 s83, 10
    s_cselect_b32 s83, 0, s83
    s_waitcnt vmcnt(20)
    s_barrier
    s_lshl_b32 s84, s83, 7
    s_add_u32 m0, s81, 0
    s_nop 0
    buffer_load_dwordx4 v12, s[44:47], s84 offen  lds
    s_add_u32 m0, m0, 1024
    s_nop 0
    buffer_load_dwordx4 v14, s[44:47], s84 offen  lds
    s_add_u32 m0, s81, 4096
    s_add_u32 s84, s84, 40960
    buffer_load_dwordx4 v12, s[44:47], s84 offen  lds
    s_add_u32 m0, m0, 1024
    s_nop 0
    buffer_load_dwordx4 v14, s[44:47], s84 offen  lds
    s_add_u32 m0, s81, 8192
    s_add_u32 s84, s84, 40960
    buffer_load_dwordx4 v12, s[44:47], s84 offen  lds
    s_add_u32 m0, m0, 1024
    s_nop 0
    buffer_load_dwordx4 v14, s[44:47], s84 offen  lds
    s_add_u32 m0, s81, 12288
    s_add_u32 s84, s84, 40960
    buffer_load_dwordx4 v12, s[44:47], s84 offen  lds
    s_add_u32 m0, m0, 1024
    s_nop 0
    buffer_load_dwordx4 v14, s[44:47], s84 offen  lds
    s_mul_i32 s85, s83, s75
    s_add_u32 m0, s82, 0
    s_nop 0
    buffer_load_dwordx4 v13, s[48:51], s85 offen  lds
    s_add_u32 m0, m0, s79
    s_add_u32 s80, s85, s77
    buffer_load_dwordx4 v15, s[48:51], s85 offen  lds
    s_add_u32 m0, m0, s78
    s_nop 0
    buffer_load_dwordx4 v15, s[52:55], s80 offen  lds
    s_sub_u32 m0, m0, s79
    s_nop 0
    buffer_load_dwordx4 v13, s[52:55], s80 offen  lds
    s_add_u32 m0, s82, 8192
    s_add_u32 s85, s85, s76
    buffer_load_dwordx4 v13, s[48:51], s85 offen  lds
    s_add_u32 m0, m0, s79
    s_add_u32 s80, s85, s77
    buffer_load_dwordx4 v15, s[48:51], s85 offen  lds
    s_add_u32 m0, m0, s78
    s_nop 0
    buffer_load_dwordx4 v15, s[52:55], s80 offen  lds
    s_sub_u32 m0, m0, s79
    s_nop 0
    buffer_load_dwordx4 v13, s[52:55], s80 offen  lds
    s_add_u32 m0, s82, 16384
    s_add_u32 s85, s85, s76
    buffer_load_dwordx4 v13, s[48:51], s85 offen  lds
    s_add_u32 m0, m0, s79
    s_add_u32 s80, s85, s77
    buffer_load_dwordx4 v15, s[48:51], s85 offen  lds
    s_add_u32 m0, m0, s78
    s_nop 0
    buffer_load_dwordx4 v15, s[52:55], s80 offen  lds
    s_sub_u32 m0, m0, s79
    s_nop 0
    buffer_load_dwordx4 v13, s[52:55], s80 offen  lds
    s_add_u32 s83, s83, 1
    s_cmp_eq_u32 s83, 10
    s_cselect_b32 s83, 0, s83
    s_waitcnt vmcnt(20)
    s_barrier
    s_lshl_b32 s84, s83, 7
    s_add_u32 m0, s81, 40960
    s_nop 0
    buffer_load_dwordx4 v12, s[44:47], s84 offen  lds
    s_add_u32 m0, m0, 1024
    s_nop 0
    buffer_load_dwordx4 v14, s[44:47], s84 offen  lds
    s_add_u32 m0, s81, 45056
    s_add_u32 s84, s84, 40960
    buffer_load_dwordx4 v12, s[44:47], s84 offen  lds
    s_add_u32 m0, m0, 1024
    s_nop 0
    buffer_load_dwordx4 v14, s[44:47], s84 offen  lds
    s_add_u32 m0, s81, 49152
    s_add_u32 s84, s84, 40960
    buffer_load_dwordx4 v12, s[44:47], s84 offen  lds
    s_add_u32 m0, m0, 1024
    s_nop 0
    buffer_load_dwordx4 v14, s[44:47], s84 offen  lds
    s_add_u32 m0, s81, 53248
    s_add_u32 s84, s84, 40960
    buffer_load_dwordx4 v12, s[44:47], s84 offen  lds
    s_add_u32 m0, m0, 1024
    s_nop 0
    buffer_load_dwordx4 v14, s[44:47], s84 offen  lds
    s_mul_i32 s85, s83, s75
    s_add_u32 m0, s82, 40960
    s_nop 0
    buffer_load_dwordx4 v13, s[48:51], s85 offen  lds
    s_add_u32 m0, m0, s79
    s_add_u32 s80, s85, s77
    buffer_load_dwordx4 v15, s[48:51], s85 offen  lds
    s_add_u32 m0, m0, s78
    s_nop 0
    buffer_load_dwordx4 v15, s[52:55], s80 offen  lds
    s_sub_u32 m0, m0, s79
    s_nop 0
    buffer_load_dwordx4 v13, s[52:55], s80 offen  lds
    s_add_u32 m0, s82, 49152
    s_add_u32 s85, s85, s76
    buffer_load_dwordx4 v13, s[48:51], s85 offen  lds
    s_add_u32 m0, m0, s79
    s_add_u32 s80, s85, s77
    buffer_load_dwordx4 v15, s[48:51], s85 offen  lds
    s_add_u32 m0, m0, s78
    s_nop 0
    buffer_load_dwordx4 v15, s[52:55], s80 offen  lds
    s_sub_u32 m0, m0, s79
    s_nop 0
    buffer_load_dwordx4 v13, s[52:55], s80 offen  lds
    s_add_u32 m0, s82, 57344
    s_add_u32 s85, s85, s76
    buffer_load_dwordx4 v13, s[48:51], s85 offen  lds
    s_add_u32 m0, m0, s79
    s_add_u32 s80, s85, s77
    buffer_load_dwordx4 v15, s[48:51], s85 offen  lds
    s_add_u32 m0, m0, s78
    s_nop 0
    buffer_load_dwordx4 v15, s[52:55], s80 offen  lds
    s_sub_u32 m0, m0, s79
    s_nop 0
    buffer_load_dwordx4 v13, s[52:55], s80 offen  lds
    s_add_u32 s83, s83, 1
    s_cmp_eq_u32 s83, 10
    s_cselect_b32 s83, 0, s83
    s_waitcnt vmcnt(20)
    s_barrier
    s_lshl_b32 s84, s83, 7
    s_add_u32 m0, s81, 81920
    s_nop 0
    buffer_load_dwordx4 v12, s[44:47], s84 offen  lds
    s_add_u32 m0, m0, 1024
    s_nop 0
    buffer_load_dwordx4 v14, s[44:47], s84 offen  lds
    s_add_u32 m0, s81, 86016
    s_add_u32 s84, s84, 40960
    buffer_load_dwordx4 v12, s[44:47], s84 offen  lds
    s_add_u32 m0, m0, 1024
    s_nop 0
    buffer_load_dwordx4 v14, s[44:47], s84 offen  lds
    s_add_u32 m0, s81, 90112
    s_add_u32 s84, s84, 40960
    buffer_load_dwordx4 v12, s[44:47], s84 offen  lds
    s_add_u32 m0, m0, 1024
    s_nop 0
    buffer_load_dwordx4 v14, s[44:47], s84 offen  lds
    s_add_u32 m0, s81, 94208
    s_add_u32 s84, s84, 40960
    buffer_load_dwordx4 v12, s[44:47], s84 offen  lds
    s_add_u32 m0, m0, 1024
    s_nop 0
    buffer_load_dwordx4 v14, s[44:47], s84 offen  lds
    s_mul_i32 s85, s83, s75
    s_add_u32 m0, s82, 81920
    s_nop 0
    buffer_load_dwordx4 v13, s[48:51], s85 offen  lds
    s_add_u32 m0, m0, s79
    s_add_u32 s80, s85, s77
    buffer_load_dwordx4 v15, s[48:51], s85 offen  lds
    s_add_u32 m0, m0, s78
    s_nop 0
    buffer_load_dwordx4 v15, s[52:55], s80 offen  lds
    s_sub_u32 m0, m0, s79
    s_nop 0
    buffer_load_dwordx4 v13, s[52:55], s80 offen  lds
    s_add_u32 m0, s82, 90112
    s_add_u32 s85, s85, s76
    buffer_load_dwordx4 v13, s[48:51], s85 offen  lds
    s_add_u32 m0, m0, s79
    s_add_u32 s80, s85, s77
    buffer_load_dwordx4 v15, s[48:51], s85 offen  lds
    s_add_u32 m0, m0, s78
    s_nop 0
    buffer_load_dwordx4 v15, s[52:55], s80 offen  lds
    s_sub_u32 m0, m0, s79
    s_nop 0
    buffer_load_dwordx4 v13, s[52:55], s80 offen  lds
    s_add_u32 m0, s82, 98304
    s_add_u32 s85, s85, s76
    buffer_load_dwordx4 v13, s[48:51], s85 offen  lds
    s_add_u32 m0, m0, s79
    s_add_u32 s80, s85, s77
    buffer_load_dwordx4 v15, s[48:51], s85 offen  lds
    s_add_u32 m0, m0, s78
    s_nop 0
    buffer_load_dwordx4 v15, s[52:55], s80 offen  lds
    s_sub_u32 m0, m0, s79
    s_nop 0
    buffer_load_dwordx4 v13, s[52:55], s80 offen  lds
    s_add_u32 s83, s83, 1
    s_cmp_eq_u32 s83, 10
    s_cselect_b32 s83, 0, s83
    s_waitcnt vmcnt(20)
    s_barrier
    s_lshl_b32 s84, s83, 7
    s_add_u32 m0, s81, 0
    s_nop 0
    buffer_load_dwordx4 v12, s[44:47], s84 offen  lds
    s_add_u32 m0, m0, 1024
    s_nop 0
    buffer_load_dwordx4 v14, s[44:47], s84 offen  lds
    s_add_u32 m0, s81, 4096
    s_add_u32 s84, s84, 40960
    buffer_load_dwordx4 v12, s[44:47], s84 offen  lds
    s_add_u32 m0, m0, 1024
    s_nop 0
    buffer_load_dwordx4 v14, s[44:47], s84 offen  lds
    s_add_u32 m0, s81, 8192
    s_add_u32 s84, s84, 40960
    buffer_load_dwordx4 v12, s[44:47], s84 offen  lds
    s_add_u32 m0, m0, 1024
    s_nop 0
    buffer_load_dwordx4 v14, s[44:47], s84 offen  lds
    s_add_u32 m0, s81, 12288
    s_add_u32 s84, s84, 40960
    buffer_load_dwordx4 v12, s[44:47], s84 offen  lds
    s_add_u32 m0, m0, 1024
    s_nop 0
    buffer_load_dwordx4 v14, s[44:47], s84 offen  lds
    s_mul_i32 s85, s83, s75
    s_add_u32 m0, s82, 0
    s_nop 0
    buffer_load_dwordx4 v13, s[48:51], s85 offen  lds
    s_add_u32 m0, m0, s79
    s_add_u32 s80, s85, s77
    buffer_load_dwordx4 v15, s[48:51], s85 offen  lds
    s_add_u32 m0, m0, s78
    s_nop 0
    buffer_load_dwordx4 v15, s[52:55], s80 offen  lds
    s_sub_u32 m0, m0, s79
    s_nop 0
    buffer_load_dwordx4 v13, s[52:55], s80 offen  lds
    s_add_u32 m0, s82, 8192
    s_add_u32 s85, s85, s76
    buffer_load_dwordx4 v13, s[48:51], s85 offen  lds
    s_add_u32 m0, m0, s79
    s_add_u32 s80, s85, s77
    buffer_load_dwordx4 v15, s[48:51], s85 offen  lds
    s_add_u32 m0, m0, s78
    s_nop 0
    buffer_load_dwordx4 v15, s[52:55], s80 offen  lds
    s_sub_u32 m0, m0, s79
    s_nop 0
    buffer_load_dwordx4 v13, s[52:55], s80 offen  lds
    s_add_u32 m0, s82, 16384
    s_add_u32 s85, s85, s76
    buffer_load_dwordx4 v13, s[48:51], s85 offen  lds
    s_add_u32 m0, m0, s79
    s_add_u32 s80, s85, s77
    buffer_load_dwordx4 v15, s[48:51], s85 offen  lds
    s_add_u32 m0, m0, s78
    s_nop 0
    buffer_load_dwordx4 v15, s[52:55], s80 offen  lds
    s_sub_u32 m0, m0, s79
    s_nop 0
    buffer_load_dwordx4 v13, s[52:55], s80 offen  lds
    s_add_u32 s83, s83, 1
    s_cmp_eq_u32 s83, 10
    s_cselect_b32 s83, 0, s83
    s_waitcnt vmcnt(20)
    s_barrier
    s_lshl_b32 s84, s83, 7
    s_add_u32 m0, s81, 40960
    s_nop 0
    buffer_load_dwordx4 v12, s[44:47], s84 offen  lds
    s_add_u32 m0, m0, 1024
    s_nop 0
    buffer_load_dwordx4 v14, s[44:47], s84 offen  lds
    s_add_u32 m0, s81, 45056
    s_add_u32 s84, s84, 40960
    buffer_load_dwordx4 v12, s[44:47], s84 offen  lds
    s_add_u32 m0, m0, 1024
    s_nop 0
    buffer_load_dwordx4 v14, s[44:47], s84 offen  lds
    s_add_u32 m0, s81, 49152
    s_add_u32 s84, s84, 40960
    buffer_load_dwordx4 v12, s[44:47], s84 offen  lds
    s_add_u32 m0, m0, 1024
    s_nop 0
    buffer_load_dwordx4 v14, s[44:47], s84 offen  lds
    s_add_u32 m0, s81, 53248
    s_add_u32 s84, s84, 40960
    buffer_load_dwordx4 v12, s[44:47], s84 offen  lds
    s_add_u32 m0, m0, 1024
    s_nop 0
    buffer_load_dwordx4 v14, s[44:47], s84 offen  lds
    s_mul_i32 s85, s83, s75
    s_add_u32 m0, s82, 40960
    s_nop 0
    buffer_load_dwordx4 v13, s[48:51], s85 offen  lds
    s_add_u32 m0, m0, s79
    s_add_u32 s80, s85, s77
    buffer_load_dwordx4 v15, s[48:51], s85 offen  lds
    s_add_u32 m0, m0, s78
    s_nop 0
    buffer_load_dwordx4 v15, s[52:55], s80 offen  lds
    s_sub_u32 m0, m0, s79
    s_nop 0
    buffer_load_dwordx4 v13, s[52:55], s80 offen  lds
    s_add_u32 m0, s82, 49152
    s_add_u32 s85, s85, s76
    buffer_load_dwordx4 v13, s[48:51], s85 offen  lds
    s_add_u32 m0, m0, s79
    s_add_u32 s80, s85, s77
    buffer_load_dwordx4 v15, s[48:51], s85 offen  lds
    s_add_u32 m0, m0, s78
    s_nop 0
    buffer_load_dwordx4 v15, s[52:55], s80 offen  lds
    s_sub_u32 m0, m0, s79
    s_nop 0
    buffer_load_dwordx4 v13, s[52:55], s80 offen  lds
    s_add_u32 m0, s82, 57344
    s_add_u32 s85, s85, s76
    buffer_load_dwordx4 v13, s[48:51], s85 offen  lds
    s_add_u32 m0, m0, s79
    s_add_u32 s80, s85, s77
    buffer_load_dwordx4 v15, s[48:51], s85 offen  lds
    s_add_u32 m0, m0, s78
    s_nop 0
    buffer_load_dwordx4 v15, s[52:55], s80 offen  lds
    s_sub_u32 m0, m0, s79
    s_nop 0
    buffer_load_dwordx4 v13, s[52:55], s80 offen  lds
    s_add_u32 s83, s83, 1
    s_cmp_eq_u32 s83, 10
    s_cselect_b32 s83, 0, s83
    s_waitcnt vmcnt(20)
    s_barrier
    s_lshl_b32 s84, s83, 7
    s_add_u32 m0, s81, 81920
    s_nop 0
    buffer_load_dwordx4 v12, s[44:47], s84 offen  lds
    s_add_u32 m0, m0, 1024
    s_nop 0
    buffer_load_dwordx4 v14, s[44:47], s84 offen  lds
    s_add_u32 m0, s81, 86016
    s_add_u32 s84, s84, 40960
    buffer_load_dwordx4 v12, s[44:47], s84 offen  lds
    s_add_u32 m0, m0, 1024
    s_nop 0
    buffer_load_dwordx4 v14, s[44:47], s84 offen  lds
    s_add_u32 m0, s81, 90112
    s_add_u32 s84, s84, 40960
    buffer_load_dwordx4 v12, s[44:47], s84 offen  lds
    s_add_u32 m0, m0, 1024
    s_nop 0
    buffer_load_dwordx4 v14, s[44:47], s84 offen  lds
    s_add_u32 m0, s81, 94208
    s_add_u32 s84, s84, 40960
    buffer_load_dwordx4 v12, s[44:47], s84 offen  lds
    s_add_u32 m0, m0, 1024
    s_nop 0
    buffer_load_dwordx4 v14, s[44:47], s84 offen  lds
    s_mul_i32 s85, s83, s75
    s_add_u32 m0, s82, 81920
    s_nop 0
    buffer_load_dwordx4 v13, s[48:51], s85 offen  lds
    s_add_u32 m0, m0, s79
    s_add_u32 s80, s85, s77
    buffer_load_dwordx4 v15, s[48:51], s85 offen  lds
    s_add_u32 m0, m0, s78
    s_nop 0
    buffer_load_dwordx4 v15, s[52:55], s80 offen  lds
    s_sub_u32 m0, m0, s79
    s_nop 0
    buffer_load_dwordx4 v13, s[52:55], s80 offen  lds
    s_add_u32 m0, s82, 90112
    s_add_u32 s85, s85, s76
    buffer_load_dwordx4 v13, s[48:51], s85 offen  lds
    s_add_u32 m0, m0, s79
    s_add_u32 s80, s85, s77
    buffer_load_dwordx4 v15, s[48:51], s85 offen  lds
    s_add_u32 m0, m0, s78
    s_nop 0
    buffer_load_dwordx4 v15, s[52:55], s80 offen  lds
    s_sub_u32 m0, m0, s79
    s_nop 0
    buffer_load_dwordx4 v13, s[52:55], s80 offen  lds
    s_add_u32 m0, s82, 98304
    s_add_u32 s85, s85, s76
    buffer_load_dwordx4 v13, s[48:51], s85 offen  lds
    s_add_u32 m0, m0, s79
    s_add_u32 s80, s85, s77
    buffer_load_dwordx4 v15, s[48:51], s85 offen  lds
    s_add_u32 m0, m0, s78
    s_nop 0
    buffer_load_dwordx4 v15, s[52:55], s80 offen  lds
    s_sub_u32 m0, m0, s79
    s_nop 0
    buffer_load_dwordx4 v13, s[52:55], s80 offen  lds
    s_add_u32 s83, s83, 1
    s_cmp_eq_u32 s83, 10
    s_cselect_b32 s83, 0, s83
    s_waitcnt vmcnt(20)
    s_barrier
    s_lshl_b32 s84, s83, 7
    s_add_u32 m0, s81, 0
    s_nop 0
    buffer_load_dwordx4 v12, s[44:47], s84 offen  lds
    s_add_u32 m0, m0, 1024
    s_nop 0
    buffer_load_dwordx4 v14, s[44:47], s84 offen  lds
    s_add_u32 m0, s81, 4096
    s_add_u32 s84, s84, 40960
    buffer_load_dwordx4 v12, s[44:47], s84 offen  lds
    s_add_u32 m0, m0, 1024
    s_nop 0
    buffer_load_dwordx4 v14, s[44:47], s84 offen  lds
    s_add_u32 m0, s81, 8192
    s_add_u32 s84, s84, 40960
    buffer_load_dwordx4 v12, s[44:47], s84 offen  lds
    s_add_u32 m0, m0, 1024
    s_nop 0
    buffer_load_dwordx4 v14, s[44:47], s84 offen  lds
    s_add_u32 m0, s81, 12288
    s_add_u32 s84, s84, 40960
    buffer_load_dwordx4 v12, s[44:47], s84 offen  lds
    s_add_u32 m0, m0, 1024
    s_nop 0
    buffer_load_dwordx4 v14, s[44:47], s84 offen  lds
    s_mul_i32 s85, s83, s75
    s_add_u32 m0, s82, 0
    s_nop 0
    buffer_load_dwordx4 v13, s[48:51], s85 offen  lds
    s_add_u32 m0, m0, s79
    s_add_u32 s80, s85, s77
    buffer_load_dwordx4 v15, s[48:51], s85 offen  lds
    s_add_u32 m0, m0, s78
    s_nop 0
    buffer_load_dwordx4 v15, s[52:55], s80 offen  lds
    s_sub_u32 m0, m0, s79
    s_nop 0
    buffer_load_dwordx4 v13, s[52:55], s80 offen  lds
    s_add_u32 m0, s82, 8192
    s_add_u32 s85, s85, s76
    buffer_load_dwordx4 v13, s[48:51], s85 offen  lds
    s_add_u32 m0, m0, s79
    s_add_u32 s80, s85, s77
    buffer_load_dwordx4 v15, s[48:51], s85 offen  lds
    s_add_u32 m0, m0, s78
    s_nop 0
    buffer_load_dwordx4 v15, s[52:55], s80 offen  lds
    s_sub_u32 m0, m0, s79
    s_nop 0
    buffer_load_dwordx4 v13, s[52:55], s80 offen  lds
    s_add_u32 m0, s82, 16384
    s_add_u32 s85, s85, s76
    buffer_load_dwordx4 v13, s[48:51], s85 offen  lds
    s_add_u32 m0, m0, s79
    s_add_u32 s80, s85, s77
    buffer_load_dwordx4 v15, s[48:51], s85 offen  lds
    s_add_u32 m0, m0, s78
    s_nop 0
    buffer_load_dwordx4 v15, s[52:55], s80 offen  lds
    s_sub_u32 m0, m0, s79
    s_nop 0
    buffer_load_dwordx4 v13, s[52:55], s80 offen  lds
    s_add_u32 s83, s83, 1
    s_cmp_eq_u32 s83, 10
    s_cselect_b32 s83, 0, s83
    v_and_b32 v16, 31, v2
    v_lshl_add_u32 v16, v16, 3, s97
    v_lshlrev_b32 v16, 7, v16
    s_mov_b32 s95, 17530880
    buffer_load_dwordx2 v[18:19], v16, s[56:59], s95 offen sc1
    v_mov_b32 v17, 160776
    ds_read_b64 v[20:21], v17
    s_waitcnt vmcnt(21)
    s_barrier
    s_mov_b32 s84, 131072
K_p2l_1:
    s_waitcnt vmcnt(0) lgkmcnt(0)
    v_cmp_ne_u64 vcc, v[18:19], v[20:21]
    s_cbranch_vccz K_p2o_2
    s_sleep 2
    buffer_load_dwordx2 v[18:19], v16, s[56:59], s95 offen sc1
    s_sub_u32 s84, s84, 1
    s_cmp_lg_u32 s84, 0
    s_cbranch_scc1 K_p2l_1
K_p2o_2:
    s_add_u32 s80, s17, 0
    s_add_u32 m0, s17, 40960
    s_nop 0
    buffer_load_dwordx4 v7, s[8:11], s80 offen offset:0 sc1 lds
    buffer_load_dwordx4 v7, s[8:11], s80 offen offset:1024 sc1 lds
    buffer_load_dwordx4 v7, s[8:11], s80 offen offset:2048 sc1 lds
    buffer_load_dwordx4 v7, s[8:11], s80 offen offset:3072 sc1 lds
    s_add_u32 m0, m0, 4096
    s_nop 0
    buffer_load_dwordx4 v1, s[8:11], s80 offen sc1 lds
    s_add_u32 s80, s17, 10240
    s_add_u32 m0, s17, 51200
    s_nop 0
    buffer_load_dwordx4 v7, s[8:11], s80 offen offset:0 sc1 lds
    buffer_load_dwordx4 v7, s[8:11], s80 offen offset:1024 sc1 lds
    buffer_load_dwordx4 v7, s[8:11], s80 offen offset:2048 sc1 lds
    buffer_load_dwordx4 v7, s[8:11], s80 offen offset:3072 sc1 lds
    s_add_u32 m0, m0, 4096
    s_nop 0
    buffer_load_dwordx4 v1, s[8:11], s80 offen sc1 lds
    s_barrier
    s_add_u32 s80, s17, 20480
    s_add_u32 m0, s17, 61440
    s_nop 0
    buffer_load_dwordx4 v7, s[8:11], s80 offen offset:0 sc1 lds
    buffer_load_dwordx4 v7, s[8:11], s80 offen offset:1024 sc1 lds
    buffer_load_dwordx4 v7, s[8:11], s80 offen offset:2048 sc1 lds
    buffer_load_dwordx4 v7, s[8:11], s80 offen offset:3072 sc1 lds
    s_add_u32 m0, m0, 4096
    s_nop 0
    buffer_load_dwordx4 v1, s[8:11], s80 offen sc1 lds
    s_add_u32 s80, s17, 30720
    s_add_u32 m0, s17, 71680
    s_nop 0
    buffer_load_dwordx4 v7, s[8:11], s80 offen offset:0 sc1 lds
    buffer_load_dwordx4 v7, s[8:11], s80 offen offset:1024 sc1 lds
    buffer_load_dwordx4 v7, s[8:11], s80 offen offset:2048 sc1 lds
    buffer_load_dwordx4 v7, s[8:11], s80 offen offset:3072 sc1 lds
    s_add_u32 m0, m0, 4096
    s_nop 0
    buffer_load_dwordx4 v1, s[8:11], s80 offen sc1 lds
    s_add_u32 s80, s17, 40960
    s_add_u32 m0, s17, 81920
    s_nop 0
    buffer_load_dwordx4 v7, s[8:11], s80 offen offset:0 sc1 lds
    buffer_load_dwordx4 v7, s[8:11], s80 offen offset:1024 sc1 lds
    buffer_load_dwordx4 v7, s[8:11], s80 offen offset:2048 sc1 lds
    buffer_load_dwordx4 v7, s[8:11], s80 offen offset:3072 sc1 lds
    s_add_u32 m0, m0, 4096
    s_nop 0
    buffer_load_dwordx4 v1, s[8:11], s80 offen sc1 lds
    s_add_u32 s80, s17, 51200
    s_add_u32 m0, s17, 92160
    s_nop 0
    buffer_load_dwordx4 v7, s[8:11], s80 offen offset:0 sc1 lds
    buffer_load_dwordx4 v7, s[8:11], s80 offen offset:1024 sc1 lds
    buffer_load_dwordx4 v7, s[8:11], s80 offen offset:2048 sc1 lds
    buffer_load_dwordx4 v7, s[8:11], s80 offen offset:3072 sc1 lds
    s_add_u32 m0, m0, 4096
    s_nop 0
    buffer_load_dwordx4 v1, s[8:11], s80 offen sc1 lds
    s_barrier
    s_barrier
    s_add_u32 s80, s17, 61440
    s_add_u32 m0, s17, 0
    s_nop 0
    buffer_load_dwordx4 v7, s[8:11], s80 offen offset:0 sc1 lds
    buffer_load_dwordx4 v7, s[8:11], s80 offen offset:1024 sc1 lds
    buffer_load_dwordx4 v7, s[8:11], s80 offen offset:2048 sc1 lds
    buffer_load_dwordx4 v7, s[8:11], s80 offen offset:3072 sc1 lds
    s_add_u32 m0, m0, 4096
    s_nop 0
    buffer_load_dwordx4 v1, s[8:11], s80 offen sc1 lds
    s_add_u32 s80, s17, 71680
    s_add_u32 m0, s17, 10240
    s_nop 0
    buffer_load_dwordx4 v7, s[8:11], s80 offen offset:0 sc1 lds
    buffer_load_dwordx4 v7, s[8:11], s80 offen offset:1024 sc1 lds
    buffer_load_dwordx4 v7, s[8:11], s80 offen offset:2048 sc1 lds
    buffer_load_dwordx4 v7, s[8:11], s80 offen offset:3072 sc1 lds
    s_add_u32 m0, m0, 4096
    s_nop 0
    buffer_load_dwordx4 v1, s[8:11], s80 offen sc1 lds
    s_add_u32 s80, s17, 81920
    s_add_u32 m0, s17, 20480
    s_nop 0
    buffer_load_dwordx4 v7, s[8:11], s80 offen offset:0 sc1 lds
    buffer_load_dwordx4 v7, s[8:11], s80 offen offset:1024 sc1 lds
    buffer_load_dwordx4 v7, s[8:11], s80 offen offset:2048 sc1 lds
    buffer_load_dwordx4 v7, s[8:11], s80 offen offset:3072 sc1 lds
    s_add_u32 m0, m0, 4096
    s_nop 0
    buffer_load_dwordx4 v1, s[8:11], s80 offen sc1 lds
    s_add_u32 s80, s17, 92160
    s_add_u32 m0, s17, 30720
    s_nop 0
    buffer_load_dwordx4 v7, s[8:11], s80 offen offset:0 sc1 lds
    buffer_load_dwordx4 v7, s[8:11], s80 offen offset:1024 sc1 lds
    buffer_load_dwordx4 v7, s[8:11], s80 offen offset:2048 sc1 lds
    buffer_load_dwordx4 v7, s[8:11], s80 offen offset:3072 sc1 lds
    s_add_u32 m0, m0, 4096
    s_nop 0
    buffer_load_dwordx4 v1, s[8:11], s80 offen sc1 lds
    s_cmp_eq_u32 s39, 0
    s_cbranch_scc1 K_lf_3
    s_barrier
K_lf_3:
    s_add_u32 s80, s17, 102400
    buffer_load_dwordx4 v[116:119], v7, s[8:11], s80 offen offset:0 sc1
    buffer_load_dwordx4 v[120:123], v7, s[8:11], s80 offen offset:1024 sc1
    buffer_load_dwordx4 v[124:127], v7, s[8:11], s80 offen offset:2048 sc1
    buffer_load_dwordx4 v[128:131], v7, s[8:11], s80 offen offset:3072 sc1
    buffer_load_dwordx4 v[132:135], v1, s[8:11], s80 offen sc1
    s_add_u32 s80, s17, 112640
    buffer_load_dwordx4 v[136:139], v7, s[8:11], s80 offen offset:0 sc1
    buffer_load_dwordx4 v[140:143], v7, s[8:11], s80 offen offset:1024 sc1
    buffer_load_dwordx4 v[144:147], v7, s[8:11], s80 offen offset:2048 sc1
    buffer_load_dwordx4 v[148:151], v7, s[8:11], s80 offen offset:3072 sc1
    buffer_load_dwordx4 v[152:155], v1, s[8:11], s80 offen sc1
    s_add_u32 s80, s17, 122880
    buffer_load_dwordx4 v[156:159], v7, s[8:11], s80 offen offset:0 sc1
    buffer_load_dwordx4 v[160:163], v7, s[8:11], s80 offen offset:1024 sc1
    buffer_load_dwordx4 v[164:167], v7, s[8:11], s80 offen offset:2048 sc1
    buffer_load_dwordx4 v[168:171], v7, s[8:11], s80 offen offset:3072 sc1
    buffer_load_dwordx4 v[172:175], v1, s[8:11], s80 offen sc1
    s_add_u32 s80, s17, 133120
    buffer_load_dwordx4 v[176:179], v7, s[8:11], s80 offen offset:0 sc1
    buffer_load_dwordx4 v[180:183], v7, s[8:11], s80 offen offset:1024 sc1
    buffer_load_dwordx4 v[184:187], v7, s[8:11], s80 offen offset:2048 sc1
    buffer_load_dwordx4 v[188:191], v7, s[8:11], s80 offen offset:3072 sc1
    buffer_load_dwordx4 v[192:195], v1, s[8:11], s80 offen sc1
    s_add_u32 s80, s17, 143360
    buffer_load_dwordx4 v[196:199], v7, s[8:11], s80 offen offset:0 sc1
    buffer_load_dwordx4 v[200:203], v7, s[8:11], s80 offen offset:1024 sc1
    buffer_load_dwordx4 v[204:207], v7, s[8:11], s80 offen offset:2048 sc1
    buffer_load_dwordx4 v[208:211], v7, s[8:11], s80 offen offset:3072 sc1
    buffer_load_dwordx4 v[212:215], v1, s[8:11], s80 offen sc1
    s_add_u32 s80, s17, 153600
    buffer_load_dwordx4 v[216:219], v7, s[8:11], s80 offen offset:0 sc1
    buffer_load_dwordx4 v[220:223], v7, s[8:11], s80 offen offset:1024 sc1
    buffer_load_dwordx4 v[224:227], v7, s[8:11], s80 offen offset:2048 sc1
    buffer_load_dwordx4 v[228:231], v7, s[8:11], s80 offen offset:3072 sc1
    buffer_load_dwordx4 v[232:235], v1, s[8:11], s80 offen sc1
    s_cmp_eq_u32 s39, 0
    s_cbranch_scc1 K_lf_3b
    s_barrier
K_lf_3b:
    s_branch K_hjoin
K_notloader:
    v_and_b32 v3, 31, v2
    v_lshrrev_b32 v4, 5, v2
    v_bfe_u32 v5, v3, 1, 3
    v_xor_b32 v5, v5, v4
    v_lshlrev_b32 v5, 4, v5
    v_lshl_add_u32 v5, v3, 7, v5
    v_bfe_u32 v1, v2, 2, 2
    v_lshl_add_u32 v6, v4, 3, v1
    v_lshlrev_b32 v6, 7, v6
    v_lshrrev_b32 v1, 1, v1
    v_lshl_add_u32 v6, v1, 6, v6
    v_bfe_u32 v1, v2, 4, 1
    v_lshl_add_u32 v6, v1, 5, v6
    v_and_b32 v1, 1, v2
    v_lshl_add_u32 v6, v1, 4, v6
    v_bfe_u32 v1, v2, 1, 1
    v_lshl_add_u32 v6, v1, 3, v6
    s_waitcnt lgkmcnt(0)
    s_mov_b32 s56, s34
    s_mov_b32 s57, s35
    s_mov_b32 s58, 268435456
    s_mov_b32 s59, 0x20000
    s_cmp_eq_u32 s43, 1
    s_cbranch_scc1 K_side
    s_mov_b32 s60, s32
    s_mov_b32 s61, s33
    s_mov_b32 s62, 256
    s_mov_b32 s63, 0x20000
    v_mov_b32 v124, 0
    v_mov_b32 v125, 0
    v_mov_b32 v120, 0
    v_mov_b32 v121, 0
    v_mov_b32 v122, 0
    v_mov_b32 v123, 0
    s_mov_b32 s22, s4
    s_mov_b32 s23, s5
    s_lshl_b32 s74, s36, 1
    s_lshr_b32 s16, s38, 1
    s_add_u32 s74, s74, s16
    s_mul_i32 s74, s74, 393216
    s_and_b32 s16, s38, 1
    s_lshl_b32 s16, s16, 11
    s_add_u32 s74, s74, s16
    s_mul_i32 s16, s96, 147456
    s_add_u32 s74, s74, s16
    s_add_u32 s4, s34, s74
    s_addc_u32 s5, s35, 0
    s_mov_b32 s6, 385024
    s_mov_b32 s7, 0x20000
    s_mul_i32 s74, s97, 491520
    s_add_u32 s74, s74, 12582912
    s_mul_i32 s16, s96, 184320
    s_add_u32 s74, s74, s16
    s_add_u32 s8, s34, s74
    s_addc_u32 s9, s35, 0
    s_mov_b32 s10, 481280
    s_mov_b32 s11, 0x20000
    s_cmp_eq_u32 s96, 1
    s_cmov_b32 s6, 196608
    s_cmov_b32 s10, 245760
    s_mov_b32 s12, s30
    s_mov_b32 s13, s31
    s_mov_b32 s14, 5242880
    s_mov_b32 s15, 0x20000
    s_mul_i32 s17, s38, 5120
    v_add_u32 v1, 4096, v7
    s_cmp_eq_u32 s96, 0
    s_cselect_b32 s101, 245760, 0
    s_add_u32 s101, s101, s17
    s_lshl_b32 s74, s36, 3
    s_add_u32 s74, s74, s97
    s_lshl_b32 s19, s74, 7
    s_add_u32 s19, s19, 17694720
    s_lshl_b32 s74, s74, 2
    s_add_u32 s74, s74, s38
    s_mul_i32 s18, s74, 10240
    s_add_u32 s18, s18, 17825792
    s_cmp_lg_u32 s2, 0
    s_cbranch_scc1 K_nnonce_6
    s_cmp_lg_u32 s38, 1
    s_cbranch_scc1 K_nnonce_6
    s_memrealtime s[74:75]
    s_waitcnt lgkmcnt(0)
    s_bitset1_b32 s75, 31
    v_mov_b32 v16, s74
    v_mov_b32 v17, s75
    s_mov_b64 exec, 1
    buffer_store_dwordx2 v[16:17], v124, s[60:63], 0 offen sc1
    s_mov_b64 exec, -1
K_nnonce_6:
    v_mov_b32 v128, 0
    v_mov_b32 v129, 0
    v_mov_b32 v130, 0
    v_mov_b32 v131, 0
    v_mov_b32 v132, 0
    v_mov_b32 v133, 0
    v_mov_b32 v134, 0
    v_mov_b32 v135, 0
    v_mov_b32 v136, 0
    v_mov_b32 v137, 0
    v_mov_b32 v138, 0
    v_mov_b32 v139, 0
    v_mov_b32 v140, 0
    v_mov_b32 v141, 0
    v_mov_b32 v142, 0
    v_mov_b32 v143, 0
    v_mov_b32 v144, 0
    v_mov_b32 v145, 0
    v_mov_b32 v146, 0
    v_mov_b32 v147, 0
    v_mov_b32 v148, 0
    v_mov_b32 v149, 0
    v_mov_b32 v150, 0
    v_mov_b32 v151, 0
    v_mov_b32 v152, 0
    v_mov_b32 v153, 0
    v_mov_b32 v154, 0
    v_mov_b32 v155, 0
    v_mov_b32 v156, 0
    v_mov_b32 v157, 0
    v_mov_b32 v158, 0
    v_mov_b32 v159, 0
    v_mov_b32 v160, 0
    v_mov_b32 v161, 0
    v_mov_b32 v162, 0
    v_mov_b32 v163, 0
    v_mov_b32 v164, 0
    v_mov_b32 v165, 0
    v_mov_b32 v166, 0
    v_mov_b32 v167, 0
    v_mov_b32 v168, 0
    v_mov_b32 v169, 0
    v_mov_b32 v170, 0
    v_mov_b32 v171, 0
    v_mov_b32 v172, 0
    v_mov_b32 v173, 0
    v_mov_b32 v174, 0
    v_mov_b32 v175, 0
    v_mov_b32 v176, 0
    v_mov_b32 v177, 0
    v_mov_b32 v178, 0
    v_mov_b32 v179, 0
    v_mov_b32 v180, 0
    v_mov_b32 v181, 0
    v_mov_b32 v182, 0
    v_mov_b32 v183, 0
    v_mov_b32 v184, 0
    v_mov_b32 v185, 0
    v_mov_b32 v186, 0
    v_mov_b32 v187, 0
    v_mov_b32 v188, 0
    v_mov_b32 v189, 0
    v_mov_b32 v190, 0
    v_mov_b32 v191, 0
    v_mov_b32 v192, 0
    v_mov_b32 v193, 0
    v_mov_b32 v194, 0
    v_mov_b32 v195, 0
    v_mov_b32 v196, 0
    v_mov_b32 v197, 0
    v_mov_b32 v198, 0
    v_mov_b32 v199, 0
    v_mov_b32 v200, 0
    v_mov_b32 v201, 0
    v_mov_b32 v202, 0
    v_mov_b32 v203, 0
    v_mov_b32 v204, 0
    v_mov_b32 v205, 0
    v_mov_b32 v206, 0
    v_mov_b32 v207, 0
    v_mov_b32 v208, 0
    v_mov_b32 v209, 0
    v_mov_b32 v210, 0
    v_mov_b32 v211, 0
    v_mov_b32 v212, 0
    v_mov_b32 v213, 0
    v_mov_b32 v214, 0
    v_mov_b32 v215, 0
    v_mov_b32 v216, 0
    v_mov_b32 v217, 0
    v_mov_b32 v218, 0
    v_mov_b32 v219, 0
    v_mov_b32 v220, 0
    v_mov_b32 v221, 0
    v_mov_b32 v222, 0
    v_mov_b32 v223, 0
    s_mov_b32 s72, 0
    s_mov_b32 s73, 10
    s_mov_b32 s94, 40960
    s_cmp_eq_u32 s39, 1
    s_cbranch_scc1 K_ssm
    s_lshr_b32 s75, s38, 1
    s_and_b32 s76, s38, 1
    s_lshl_b32 s77, s75, 13
    v_xor_b32 v8, 0, v5
    v_add_u32 v8, s77, v8
    v_xor_b32 v9, 32, v5
    v_add_u32 v9, s77, v9
    v_xor_b32 v10, 64, v5
    v_add_u32 v10, s77, v10
    v_xor_b32 v11, 96, v5
    v_add_u32 v11, s77, v11
    s_mul_i32 s77, s76, 3
    s_add_u32 s77, s77, 0
    s_and_b32 s78, s77, 1
    s_lshl_b32 s78, s78, 6
    s_lshr_b32 s77, s77, 1
    s_lshl_b32 s77, s77, 13
    s_add_u32 s77, s77, 16384
    v_xor_b32 v12, s78, v6
    v_add_u32 v12, s77, v12
    s_mul_i32 s77, s76, 3
    s_add_u32 s77, s77, 1
    s_and_b32 s78, s77, 1
    s_lshl_b32 s78, s78, 6
    s_lshr_b32 s77, s77, 1
    s_lshl_b32 s77, s77, 13
    s_add_u32 s77, s77, 16384
    v_xor_b32 v13, s78, v6
    v_add_u32 v13, s77, v13
    s_mul_i32 s77, s76, 3
    s_add_u32 s77, s77, 2
    s_and_b32 s78, s77, 1
    s_lshl_b32 s78, s78, 6
    s_lshr_b32 s77, s77, 1
    s_lshl_b32 s77, s77, 13
    s_add_u32 s77, s77, 16384
    v_xor_b32 v14, s78, v6
    v_add_u32 v14, s77, v14
    s_barrier
    ds_read_b128 v[64:67], v8 offset:0
    ds_read_b64_tr_b16 v[72:73], v12 offset:0
    ds_read_b64_tr_b16 v[74:75], v12 offset:512
    ds_read_b128 v[68:71], v8 offset:4096
    ds_read_b64_tr_b16 v[76:77], v13 offset:0
    ds_read_b64_tr_b16 v[78:79], v13 offset:512
    ds_read_b64_tr_b16 v[80:81], v14 offset:0
    ds_read_b64_tr_b16 v[82:83], v14 offset:512
K_ffn_loop:
    s_add_u32 s72, s72, 1
    s_cmp_eq_u32 s72, 3
    s_cselect_b32 s72, 0, s72
    s_cselect_b32 s74, 4294885376, s94
    s_waitcnt lgkmcnt(5)
    v_mfma_f32_32x32x16_bf16 v[128:143], v[72:75], v[64:67], v[128:143]
    ds_read_b128 v[92:95], v9 offset:0
    ds_read_b64_tr_b16 v[100:101], v12 offset:2048
    s_waitcnt lgkmcnt(6)
    v_mfma_f32_32x32x16_bf16 v[176:191], v[72:75], v[68:71], v[176:191]
    ds_read_b64_tr_b16 v[102:103], v12 offset:2560
    ds_read_b128 v[96:99], v9 offset:4096
    s_waitcnt lgkmcnt(6)
    v_mfma_f32_32x32x16_bf16 v[144:159], v[76:79], v[64:67], v[144:159]
    ds_read_b64_tr_b16 v[104:105], v13 offset:2048
    ds_read_b64_tr_b16 v[106:107], v13 offset:2560
    v_mfma_f32_32x32x16_bf16 v[192:207], v[76:79], v[68:71], v[192:207]
    ds_read_b64_tr_b16 v[108:109], v14 offset:2048
    ds_read_b64_tr_b16 v[110:111], v14 offset:2560
    s_waitcnt lgkmcnt(8)
    v_mfma_f32_32x32x16_bf16 v[160:175], v[80:83], v[64:67], v[160:175]
    v_mfma_f32_32x32x16_bf16 v[208:223], v[80:83], v[68:71], v[208:223]
    s_waitcnt lgkmcnt(5)
    v_mfma_f32_32x32x16_bf16 v[128:143], v[100:103], v[92:95], v[128:143]
    ds_read_b128 v[64:67], v10 offset:0
    ds_read_b64_tr_b16 v[72:73], v12 offset:4096
    s_waitcnt lgkmcnt(6)
    v_mfma_f32_32x32x16_bf16 v[176:191], v[100:103], v[96:99], v[176:191]
    ds_read_b64_tr_b16 v[74:75], v12 offset:4608
    ds_read_b128 v[68:71], v10 offset:4096
    s_waitcnt lgkmcnt(6)
    v_mfma_f32_32x32x16_bf16 v[144:159], v[104:107], v[92:95], v[144:159]
    ds_read_b64_tr_b16 v[76:77], v13 offset:4096
    ds_read_b64_tr_b16 v[78:79], v13 offset:4608
    v_mfma_f32_32x32x16_bf16 v[192:207], v[104:107], v[96:99], v[192:207]
    ds_read_b64_tr_b16 v[80:81], v14 offset:4096
    ds_read_b64_tr_b16 v[82:83], v14 offset:4608
    s_waitcnt lgkmcnt(8)
    v_mfma_f32_32x32x16_bf16 v[160:175], v[108:111], v[92:95], v[160:175]
    v_mfma_f32_32x32x16_bf16 v[208:223], v[108:111], v[96:99], v[208:223]
    s_waitcnt lgkmcnt(5)
    v_mfma_f32_32x32x16_bf16 v[128:143], v[72:75], v[64:67], v[128:143]
    ds_read_b128 v[92:95], v11 offset:0
    ds_read_b64_tr_b16 v[100:101], v12 offset:6144
    s_waitcnt lgkmcnt(6)
    v_mfma_f32_32x32x16_bf16 v[176:191], v[72:75], v[68:71], v[176:191]
    ds_read_b64_tr_b16 v[102:103], v12 offset:6656
    ds_read_b128 v[96:99], v11 offset:4096
    s_waitcnt lgkmcnt(6)
    v_mfma_f32_32x32x16_bf16 v[144:159], v[76:79], v[64:67], v[144:159]
    ds_read_b64_tr_b16 v[104:105], v13 offset:6144
    ds_read_b64_tr_b16 v[106:107], v13 offset:6656
    v_mfma_f32_32x32x16_bf16 v[192:207], v[76:79], v[68:71], v[192:207]
    ds_read_b64_tr_b16 v[108:109], v14 offset:6144
    ds_read_b64_tr_b16 v[110:111], v14 offset:6656
    s_waitcnt lgkmcnt(8)
    v_mfma_f32_32x32x16_bf16 v[160:175], v[80:83], v[64:67], v[160:175]
    v_add_u32 v8, s74, v8
    v_add_u32 v9, s74, v9
    v_add_u32 v10, s74, v10
    v_mfma_f32_32x32x16_bf16 v[208:223], v[80:83], v[68:71], v[208:223]
    s_waitcnt lgkmcnt(5)
    v_mfma_f32_32x32x16_bf16 v[128:143], v[100:103], v[92:95], v[128:143]
    v_add_u32 v11, s74, v11
    v_add_u32 v12, s74, v12
    v_add_u32 v13, s74, v13
    v_add_u32 v14, s74, v14
    s_waitcnt lgkmcnt(0)
    s_barrier
    v_mfma_f32_32x32x16_bf16 v[176:191], v[100:103], v[96:99], v[176:191]
    ds_read_b128 v[64:67], v8 offset:0
    ds_read_b64_tr_b16 v[72:73], v12 offset:0
    v_mfma_f32_32x32x16_bf16 v[144:159], v[104:107], v[92:95], v[144:159]
    ds_read_b64_tr_b16 v[74:75], v12 offset:512
    ds_read_b128 v[68:71], v8 offset:4096
    ds_read_b64_tr_b16 v[76:77], v13 offset:0
    v_mfma_f32_32x32x16_bf16 v[192:207], v[104:107], v[96:99], v[192:207]
    ds_read_b64_tr_b16 v[78:79], v13 offset:512
    ds_read_b64_tr_b16 v[80:81], v14 offset:0
    ds_read_b64_tr_b16 v[82:83], v14 offset:512
    v_mfma_f32_32x32x16_bf16 v[160:175], v[108:111], v[92:95], v[160:175]
    v_mfma_f32_32x32x16_bf16 v[208:223], v[108:111], v[96:99], v[208:223]
    s_sub_u32 s73, s73, 1
    s_cmp_lg_u32 s73, 0
    s_cbranch_scc1 K_ffn_loop
    s_setprio 3
    s_waitcnt vmcnt(0) lgkmcnt(0)
    s_barrier
    s_lshl_b32 s77, s75, 9
    s_add_u32 s77, s77, 143360
    v_lshl_add_u32 v20, v3, 3, s77
    ds_read_b64 v[16:17], v20
    ds_read_b64 v[18:19], v20 offset:256
    s_mul_i32 s77, s76, 384
    s_add_u32 s77, s77, 144384
    v_lshl_add_u32 v21, v4, 5, s77
    ds_read_b128 v[32:35], v21 offset:0
    ds_read_b128 v[48:51], v21 offset:768
    ds_read_b128 v[36:39], v21 offset:16
    ds_read_b128 v[52:55], v21 offset:784
    ds_read_b128 v[40:43], v21 offset:64
    ds_read_b128 v[56:59], v21 offset:832
    ds_read_b128 v[44:47], v21 offset:80
    ds_read_b128 v[60:63], v21 offset:848
    v_lshrrev_b32 v22, 4, v3
    v_lshlrev_b32 v22, 10, v22
    v_lshl_add_u32 v22, v4, 8, v22
    v_and_b32 v23, 15, v3
    v_lshl_add_u32 v22, v23, 4, v22
    s_lshl_b32 s77, s36, 1
    s_add_u32 s77, s77, s75
    s_mul_i32 s77, s77, 393216
    s_mul_i32 s78, s40, 6
    s_mul_i32 s79, s76, 3
    s_add_u32 s78, s78, s79
    s_lshl_b32 s78, s78, 12
    s_add_u32 s77, s77, s78
    s_mov_b32 s80, 3216077336
    s_mov_b32 s81, 3216077336
    v_mov_b32 v24, 1060205080
    v_mov_b32 v25, 1060205080
    s_mov_b32 s82, s77
    s_add_u32 s83, s77, 4096
    s_add_u32 s84, s77, 8192
    s_waitcnt lgkmcnt(6)
    ds_read_b128 v[64:67], v21 offset:128
    ds_read_b128 v[80:83], v21 offset:896
    ds_read_b128 v[68:71], v21 offset:144
    ds_read_b128 v[84:87], v21 offset:912
    ds_read_b128 v[72:75], v21 offset:192
    ds_read_b128 v[88:91], v21 offset:960
    ds_read_b128 v[76:79], v21 offset:208
    ds_read_b128 v[92:95], v21 offset:976
    s_waitcnt lgkmcnt(8)
    v_pk_fma_f32 v[96:97], v[16:17], v[32:33], v[48:49] op_sel_hi:[0,1,1] neg_lo:[1,0,0] neg_hi:[1,0,0]
    v_pk_fma_f32 v[98:99], v[16:17], v[34:35], v[50:51] op_sel_hi:[0,1,1] neg_lo:[1,0,0] neg_hi:[1,0,0]
    v_pk_fma_f32 v[100:101], v[16:17], v[36:37], v[52:53] op_sel_hi:[0,1,1] neg_lo:[1,0,0] neg_hi:[1,0,0]
    v_pk_fma_f32 v[102:103], v[16:17], v[38:39], v[54:55] op_sel_hi:[0,1,1] neg_lo:[1,0,0] neg_hi:[1,0,0]
    v_pk_fma_f32 v[128:129], v[16:17], v[128:129], v[96:97] op_sel:[1,0,0] op_sel_hi:[1,1,1]
    v_pk_fma_f32 v[130:131], v[16:17], v[130:131], v[98:99] op_sel:[1,0,0] op_sel_hi:[1,1,1]
    v_pk_fma_f32 v[132:133], v[16:17], v[132:133], v[100:101] op_sel:[1,0,0] op_sel_hi:[1,1,1]
    v_pk_fma_f32 v[134:135], v[16:17], v[134:135], v[102:103] op_sel:[1,0,0] op_sel_hi:[1,1,1]
    v_exp_f32 v96, v128
    v_exp_f32 v97, v129
    v_exp_f32 v98, v130
    v_exp_f32 v99, v131
    v_exp_f32 v100, v132
    v_exp_f32 v101, v133
    v_exp_f32 v102, v134
    v_exp_f32 v103, v135
    v_pk_add_f32 v[104:105], v[96:97], 2.0 op_sel_hi:[1,0]
    v_pk_add_f32 v[106:107], v[98:99], 2.0 op_sel_hi:[1,0]
    v_pk_add_f32 v[108:109], v[100:101], 2.0 op_sel_hi:[1,0]
    v_pk_add_f32 v[110:111], v[102:103], 2.0 op_sel_hi:[1,0]
    v_pk_fma_f32 v[96:97], v[96:97], v[104:105], 2.0 op_sel_hi:[1,1,0]
    v_pk_fma_f32 v[98:99], v[98:99], v[106:107], 2.0 op_sel_hi:[1,1,0]
    v_pk_fma_f32 v[100:101], v[100:101], v[108:109], 2.0 op_sel_hi:[1,1,0]
    v_pk_fma_f32 v[102:103], v[102:103], v[110:111], 2.0 op_sel_hi:[1,1,0]
    v_rcp_f32 v96, v96
    v_rcp_f32 v97, v97
    v_rcp_f32 v98, v98
    v_rcp_f32 v99, v99
    v_rcp_f32 v100, v100
    v_rcp_f32 v101, v101
    v_rcp_f32 v102, v102
    v_rcp_f32 v103, v103
    v_pk_fma_f32 v[96:97], v[96:97], s[80:81], v[24:25]
    v_pk_fma_f32 v[98:99], v[98:99], s[80:81], v[24:25]
    v_pk_fma_f32 v[100:101], v[100:101], s[80:81], v[24:25]
    v_pk_fma_f32 v[102:103], v[102:103], s[80:81], v[24:25]
    v_pk_mul_f32 v[96:97], v[96:97], v[128:129]
    v_pk_mul_f32 v[98:99], v[98:99], v[130:131]
    v_pk_mul_f32 v[100:101], v[100:101], v[132:133]
    v_pk_mul_f32 v[102:103], v[102:103], v[134:135]
    v_cvt_pk_bf16_f32 v128, v96, v97
    v_cvt_pk_bf16_f32 v129, v98, v99
    v_cvt_pk_bf16_f32 v130, v100, v101
    v_cvt_pk_bf16_f32 v131, v102, v103
    buffer_store_dwordx4 v[128:131], v22, s[56:59], s82 offen offset:0 sc1
    v_pk_fma_f32 v[96:97], v[16:17], v[40:41], v[56:57] op_sel_hi:[0,1,1] neg_lo:[1,0,0] neg_hi:[1,0,0]
    v_pk_fma_f32 v[98:99], v[16:17], v[42:43], v[58:59] op_sel_hi:[0,1,1] neg_lo:[1,0,0] neg_hi:[1,0,0]
    v_pk_fma_f32 v[100:101], v[16:17], v[44:45], v[60:61] op_sel_hi:[0,1,1] neg_lo:[1,0,0] neg_hi:[1,0,0]
    v_pk_fma_f32 v[102:103], v[16:17], v[46:47], v[62:63] op_sel_hi:[0,1,1] neg_lo:[1,0,0] neg_hi:[1,0,0]
    v_pk_fma_f32 v[136:137], v[16:17], v[136:137], v[96:97] op_sel:[1,0,0] op_sel_hi:[1,1,1]
    v_pk_fma_f32 v[138:139], v[16:17], v[138:139], v[98:99] op_sel:[1,0,0] op_sel_hi:[1,1,1]
    v_pk_fma_f32 v[140:141], v[16:17], v[140:141], v[100:101] op_sel:[1,0,0] op_sel_hi:[1,1,1]
    v_pk_fma_f32 v[142:143], v[16:17], v[142:143], v[102:103] op_sel:[1,0,0] op_sel_hi:[1,1,1]
    v_exp_f32 v96, v136
    v_exp_f32 v97, v137
    v_exp_f32 v98, v138
    v_exp_f32 v99, v139
    v_exp_f32 v100, v140
    v_exp_f32 v101, v141
    v_exp_f32 v102, v142
    v_exp_f32 v103, v143
    v_pk_add_f32 v[104:105], v[96:97], 2.0 op_sel_hi:[1,0]
    v_pk_add_f32 v[106:107], v[98:99], 2.0 op_sel_hi:[1,0]
    v_pk_add_f32 v[108:109], v[100:101], 2.0 op_sel_hi:[1,0]
    v_pk_add_f32 v[110:111], v[102:103], 2.0 op_sel_hi:[1,0]
    v_pk_fma_f32 v[96:97], v[96:97], v[104:105], 2.0 op_sel_hi:[1,1,0]
    v_pk_fma_f32 v[98:99], v[98:99], v[106:107], 2.0 op_sel_hi:[1,1,0]
    v_pk_fma_f32 v[100:101], v[100:101], v[108:109], 2.0 op_sel_hi:[1,1,0]
    v_pk_fma_f32 v[102:103], v[102:103], v[110:111], 2.0 op_sel_hi:[1,1,0]
    v_rcp_f32 v96, v96
    v_rcp_f32 v97, v97
    v_rcp_f32 v98, v98
    v_rcp_f32 v99, v99
    v_rcp_f32 v100, v100
    v_rcp_f32 v101, v101
    v_rcp_f32 v102, v102
    v_rcp_f32 v103, v103
    v_pk_fma_f32 v[96:97], v[96:97], s[80:81], v[24:25]
    v_pk_fma_f32 v[98:99], v[98:99], s[80:81], v[24:25]
    v_pk_fma_f32 v[100:101], v[100:101], s[80:81], v[24:25]
    v_pk_fma_f32 v[102:103], v[102:103], s[80:81], v[24:25]
    v_pk_mul_f32 v[96:97], v[96:97], v[136:137]
    v_pk_mul_f32 v[98:99], v[98:99], v[138:139]
    v_pk_mul_f32 v[100:101], v[100:101], v[140:141]
    v_pk_mul_f32 v[102:103], v[102:103], v[142:143]
    v_cvt_pk_bf16_f32 v136, v96, v97
    v_cvt_pk_bf16_f32 v137, v98, v99
    v_cvt_pk_bf16_f32 v138, v100, v101
    v_cvt_pk_bf16_f32 v139, v102, v103
    buffer_store_dwordx4 v[136:139], v22, s[56:59], s82 offen offset:512 sc1
    v_pk_fma_f32 v[96:97], v[18:19], v[32:33], v[48:49] op_sel_hi:[0,1,1] neg_lo:[1,0,0] neg_hi:[1,0,0]
    v_pk_fma_f32 v[98:99], v[18:19], v[34:35], v[50:51] op_sel_hi:[0,1,1] neg_lo:[1,0,0] neg_hi:[1,0,0]
    v_pk_fma_f32 v[100:101], v[18:19], v[36:37], v[52:53] op_sel_hi:[0,1,1] neg_lo:[1,0,0] neg_hi:[1,0,0]
    v_pk_fma_f32 v[102:103], v[18:19], v[38:39], v[54:55] op_sel_hi:[0,1,1] neg_lo:[1,0,0] neg_hi:[1,0,0]
    v_pk_fma_f32 v[176:177], v[18:19], v[176:177], v[96:97] op_sel:[1,0,0] op_sel_hi:[1,1,1]
    v_pk_fma_f32 v[178:179], v[18:19], v[178:179], v[98:99] op_sel:[1,0,0] op_sel_hi:[1,1,1]
    v_pk_fma_f32 v[180:181], v[18:19], v[180:181], v[100:101] op_sel:[1,0,0] op_sel_hi:[1,1,1]
    v_pk_fma_f32 v[182:183], v[18:19], v[182:183], v[102:103] op_sel:[1,0,0] op_sel_hi:[1,1,1]
    v_exp_f32 v96, v176
    v_exp_f32 v97, v177
    v_exp_f32 v98, v178
    v_exp_f32 v99, v179
    v_exp_f32 v100, v180
    v_exp_f32 v101, v181
    v_exp_f32 v102, v182
    v_exp_f32 v103, v183
    v_pk_add_f32 v[104:105], v[96:97], 2.0 op_sel_hi:[1,0]
    v_pk_add_f32 v[106:107], v[98:99], 2.0 op_sel_hi:[1,0]
    v_pk_add_f32 v[108:109], v[100:101], 2.0 op_sel_hi:[1,0]
    v_pk_add_f32 v[110:111], v[102:103], 2.0 op_sel_hi:[1,0]
    v_pk_fma_f32 v[96:97], v[96:97], v[104:105], 2.0 op_sel_hi:[1,1,0]
    v_pk_fma_f32 v[98:99], v[98:99], v[106:107], 2.0 op_sel_hi:[1,1,0]
    v_pk_fma_f32 v[100:101], v[100:101], v[108:109], 2.0 op_sel_hi:[1,1,0]
    v_pk_fma_f32 v[102:103], v[102:103], v[110:111], 2.0 op_sel_hi:[1,1,0]
    v_rcp_f32 v96, v96
    v_rcp_f32 v97, v97
    v_rcp_f32 v98, v98
    v_rcp_f32 v99, v99
    v_rcp_f32 v100, v100
    v_rcp_f32 v101, v101
    v_rcp_f32 v102, v102
    v_rcp_f32 v103, v103
    v_pk_fma_f32 v[96:97], v[96:97], s[80:81], v[24:25]
    v_pk_fma_f32 v[98:99], v[98:99], s[80:81], v[24:25]
    v_pk_fma_f32 v[100:101], v[100:101], s[80:81], v[24:25]
    v_pk_fma_f32 v[102:103], v[102:103], s[80:81], v[24:25]
    v_pk_mul_f32 v[96:97], v[96:97], v[176:177]
    v_pk_mul_f32 v[98:99], v[98:99], v[178:179]
    v_pk_mul_f32 v[100:101], v[100:101], v[180:181]
    v_pk_mul_f32 v[102:103], v[102:103], v[182:183]
    v_cvt_pk_bf16_f32 v176, v96, v97
    v_cvt_pk_bf16_f32 v177, v98, v99
    v_cvt_pk_bf16_f32 v178, v100, v101
    v_cvt_pk_bf16_f32 v179, v102, v103
    buffer_store_dwordx4 v[176:179], v22, s[56:59], s82 offen offset:2048 sc1
    v_pk_fma_f32 v[96:97], v[18:19], v[40:41], v[56:57] op_sel_hi:[0,1,1] neg_lo:[1,0,0] neg_hi:[1,0,0]
    v_pk_fma_f32 v[98:99], v[18:19], v[42:43], v[58:59] op_sel_hi:[0,1,1] neg_lo:[1,0,0] neg_hi:[1,0,0]
    v_pk_fma_f32 v[100:101], v[18:19], v[44:45], v[60:61] op_sel_hi:[0,1,1] neg_lo:[1,0,0] neg_hi:[1,0,0]
    v_pk_fma_f32 v[102:103], v[18:19], v[46:47], v[62:63] op_sel_hi:[0,1,1] neg_lo:[1,0,0] neg_hi:[1,0,0]
    v_pk_fma_f32 v[184:185], v[18:19], v[184:185], v[96:97] op_sel:[1,0,0] op_sel_hi:[1,1,1]
    v_pk_fma_f32 v[186:187], v[18:19], v[186:187], v[98:99] op_sel:[1,0,0] op_sel_hi:[1,1,1]
    v_pk_fma_f32 v[188:189], v[18:19], v[188:189], v[100:101] op_sel:[1,0,0] op_sel_hi:[1,1,1]
    v_pk_fma_f32 v[190:191], v[18:19], v[190:191], v[102:103] op_sel:[1,0,0] op_sel_hi:[1,1,1]
    v_exp_f32 v96, v184
    v_exp_f32 v97, v185
    v_exp_f32 v98, v186
    v_exp_f32 v99, v187
    v_exp_f32 v100, v188
    v_exp_f32 v101, v189
    v_exp_f32 v102, v190
    v_exp_f32 v103, v191
    v_pk_add_f32 v[104:105], v[96:97], 2.0 op_sel_hi:[1,0]
    v_pk_add_f32 v[106:107], v[98:99], 2.0 op_sel_hi:[1,0]
    v_pk_add_f32 v[108:109], v[100:101], 2.0 op_sel_hi:[1,0]
    v_pk_add_f32 v[110:111], v[102:103], 2.0 op_sel_hi:[1,0]
    v_pk_fma_f32 v[96:97], v[96:97], v[104:105], 2.0 op_sel_hi:[1,1,0]
    v_pk_fma_f32 v[98:99], v[98:99], v[106:107], 2.0 op_sel_hi:[1,1,0]
    v_pk_fma_f32 v[100:101], v[100:101], v[108:109], 2.0 op_sel_hi:[1,1,0]
    v_pk_fma_f32 v[102:103], v[102:103], v[110:111], 2.0 op_sel_hi:[1,1,0]
    v_rcp_f32 v96, v96
    v_rcp_f32 v97, v97
    v_rcp_f32 v98, v98
    v_rcp_f32 v99, v99
    v_rcp_f32 v100, v100
    v_rcp_f32 v101, v101
    v_rcp_f32 v102, v102
    v_rcp_f32 v103, v103
    v_pk_fma_f32 v[96:97], v[96:97], s[80:81], v[24:25]
    v_pk_fma_f32 v[98:99], v[98:99], s[80:81], v[24:25]
    v_pk_fma_f32 v[100:101], v[100:101], s[80:81], v[24:25]
    v_pk_fma_f32 v[102:103], v[102:103], s[80:81], v[24:25]
    v_pk_mul_f32 v[96:97], v[96:97], v[184:185]
    v_pk_mul_f32 v[98:99], v[98:99], v[186:187]
    v_pk_mul_f32 v[100:101], v[100:101], v[188:189]
    v_pk_mul_f32 v[102:103], v[102:103], v[190:191]
    v_cvt_pk_bf16_f32 v184, v96, v97
    v_cvt_pk_bf16_f32 v185, v98, v99
    v_cvt_pk_bf16_f32 v186, v100, v101
    v_cvt_pk_bf16_f32 v187, v102, v103
    buffer_store_dwordx4 v[184:187], v22, s[56:59], s82 offen offset:2560 sc1
    s_waitcnt lgkmcnt(6)
    ds_read_b128 v[32:35], v21 offset:256
    ds_read_b128 v[48:51], v21 offset:1024
    ds_read_b128 v[36:39], v21 offset:272
    ds_read_b128 v[52:55], v21 offset:1040
    ds_read_b128 v[40:43], v21 offset:320
    ds_read_b128 v[56:59], v21 offset:1088
    ds_read_b128 v[44:47], v21 offset:336
    ds_read_b128 v[60:63], v21 offset:1104
    s_waitcnt lgkmcnt(8)
    v_pk_fma_f32 v[96:97], v[16:17], v[64:65], v[80:81] op_sel_hi:[0,1,1] neg_lo:[1,0,0] neg_hi:[1,0,0]
    v_pk_fma_f32 v[98:99], v[16:17], v[66:67], v[82:83] op_sel_hi:[0,1,1] neg_lo:[1,0,0] neg_hi:[1,0,0]
    v_pk_fma_f32 v[100:101], v[16:17], v[68:69], v[84:85] op_sel_hi:[0,1,1] neg_lo:[1,0,0] neg_hi:[1,0,0]
    v_pk_fma_f32 v[102:103], v[16:17], v[70:71], v[86:87] op_sel_hi:[0,1,1] neg_lo:[1,0,0] neg_hi:[1,0,0]
    v_pk_fma_f32 v[144:145], v[16:17], v[144:145], v[96:97] op_sel:[1,0,0] op_sel_hi:[1,1,1]
    v_pk_fma_f32 v[146:147], v[16:17], v[146:147], v[98:99] op_sel:[1,0,0] op_sel_hi:[1,1,1]
    v_pk_fma_f32 v[148:149], v[16:17], v[148:149], v[100:101] op_sel:[1,0,0] op_sel_hi:[1,1,1]
    v_pk_fma_f32 v[150:151], v[16:17], v[150:151], v[102:103] op_sel:[1,0,0] op_sel_hi:[1,1,1]
    v_exp_f32 v96, v144
    v_exp_f32 v97, v145
    v_exp_f32 v98, v146
    v_exp_f32 v99, v147
    v_exp_f32 v100, v148
    v_exp_f32 v101, v149
    v_exp_f32 v102, v150
    v_exp_f32 v103, v151
    v_pk_add_f32 v[104:105], v[96:97], 2.0 op_sel_hi:[1,0]
    v_pk_add_f32 v[106:107], v[98:99], 2.0 op_sel_hi:[1,0]
    v_pk_add_f32 v[108:109], v[100:101], 2.0 op_sel_hi:[1,0]
    v_pk_add_f32 v[110:111], v[102:103], 2.0 op_sel_hi:[1,0]
    v_pk_fma_f32 v[96:97], v[96:97], v[104:105], 2.0 op_sel_hi:[1,1,0]
    v_pk_fma_f32 v[98:99], v[98:99], v[106:107], 2.0 op_sel_hi:[1,1,0]
    v_pk_fma_f32 v[100:101], v[100:101], v[108:109], 2.0 op_sel_hi:[1,1,0]
    v_pk_fma_f32 v[102:103], v[102:103], v[110:111], 2.0 op_sel_hi:[1,1,0]
    v_rcp_f32 v96, v96
    v_rcp_f32 v97, v97
    v_rcp_f32 v98, v98
    v_rcp_f32 v99, v99
    v_rcp_f32 v100, v100
    v_rcp_f32 v101, v101
    v_rcp_f32 v102, v102
    v_rcp_f32 v103, v103
    v_pk_fma_f32 v[96:97], v[96:97], s[80:81], v[24:25]
    v_pk_fma_f32 v[98:99], v[98:99], s[80:81], v[24:25]
    v_pk_fma_f32 v[100:101], v[100:101], s[80:81], v[24:25]
    v_pk_fma_f32 v[102:103], v[102:103], s[80:81], v[24:25]
    v_pk_mul_f32 v[96:97], v[96:97], v[144:145]
    v_pk_mul_f32 v[98:99], v[98:99], v[146:147]
    v_pk_mul_f32 v[100:101], v[100:101], v[148:149]
    v_pk_mul_f32 v[102:103], v[102:103], v[150:151]
    v_cvt_pk_bf16_f32 v144, v96, v97
    v_cvt_pk_bf16_f32 v145, v98, v99
    v_cvt_pk_bf16_f32 v146, v100, v101
    v_cvt_pk_bf16_f32 v147, v102, v103
    buffer_store_dwordx4 v[144:147], v22, s[56:59], s83 offen offset:0 sc1
    v_pk_fma_f32 v[96:97], v[16:17], v[72:73], v[88:89] op_sel_hi:[0,1,1] neg_lo:[1,0,0] neg_hi:[1,0,0]
    v_pk_fma_f32 v[98:99], v[16:17], v[74:75], v[90:91] op_sel_hi:[0,1,1] neg_lo:[1,0,0] neg_hi:[1,0,0]
    v_pk_fma_f32 v[100:101], v[16:17], v[76:77], v[92:93] op_sel_hi:[0,1,1] neg_lo:[1,0,0] neg_hi:[1,0,0]
    v_pk_fma_f32 v[102:103], v[16:17], v[78:79], v[94:95] op_sel_hi:[0,1,1] neg_lo:[1,0,0] neg_hi:[1,0,0]
    v_pk_fma_f32 v[152:153], v[16:17], v[152:153], v[96:97] op_sel:[1,0,0] op_sel_hi:[1,1,1]
    v_pk_fma_f32 v[154:155], v[16:17], v[154:155], v[98:99] op_sel:[1,0,0] op_sel_hi:[1,1,1]
    v_pk_fma_f32 v[156:157], v[16:17], v[156:157], v[100:101] op_sel:[1,0,0] op_sel_hi:[1,1,1]
    v_pk_fma_f32 v[158:159], v[16:17], v[158:159], v[102:103] op_sel:[1,0,0] op_sel_hi:[1,1,1]
    v_exp_f32 v96, v152
    v_exp_f32 v97, v153
    v_exp_f32 v98, v154
    v_exp_f32 v99, v155
    v_exp_f32 v100, v156
    v_exp_f32 v101, v157
    v_exp_f32 v102, v158
    v_exp_f32 v103, v159
    v_pk_add_f32 v[104:105], v[96:97], 2.0 op_sel_hi:[1,0]
    v_pk_add_f32 v[106:107], v[98:99], 2.0 op_sel_hi:[1,0]
    v_pk_add_f32 v[108:109], v[100:101], 2.0 op_sel_hi:[1,0]
    v_pk_add_f32 v[110:111], v[102:103], 2.0 op_sel_hi:[1,0]
    v_pk_fma_f32 v[96:97], v[96:97], v[104:105], 2.0 op_sel_hi:[1,1,0]
    v_pk_fma_f32 v[98:99], v[98:99], v[106:107], 2.0 op_sel_hi:[1,1,0]
    v_pk_fma_f32 v[100:101], v[100:101], v[108:109], 2.0 op_sel_hi:[1,1,0]
    v_pk_fma_f32 v[102:103], v[102:103], v[110:111], 2.0 op_sel_hi:[1,1,0]
    v_rcp_f32 v96, v96
    v_rcp_f32 v97, v97
    v_rcp_f32 v98, v98
    v_rcp_f32 v99, v99
    v_rcp_f32 v100, v100
    v_rcp_f32 v101, v101
    v_rcp_f32 v102, v102
    v_rcp_f32 v103, v103
    v_pk_fma_f32 v[96:97], v[96:97], s[80:81], v[24:25]
    v_pk_fma_f32 v[98:99], v[98:99], s[80:81], v[24:25]
    v_pk_fma_f32 v[100:101], v[100:101], s[80:81], v[24:25]
    v_pk_fma_f32 v[102:103], v[102:103], s[80:81], v[24:25]
    v_pk_mul_f32 v[96:97], v[96:97], v[152:153]
    v_pk_mul_f32 v[98:99], v[98:99], v[154:155]
    v_pk_mul_f32 v[100:101], v[100:101], v[156:157]
    v_pk_mul_f32 v[102:103], v[102:103], v[158:159]
    v_cvt_pk_bf16_f32 v152, v96, v97
    v_cvt_pk_bf16_f32 v153, v98, v99
    v_cvt_pk_bf16_f32 v154, v100, v101
    v_cvt_pk_bf16_f32 v155, v102, v103
    buffer_store_dwordx4 v[152:155], v22, s[56:59], s83 offen offset:512 sc1
    v_pk_fma_f32 v[96:97], v[18:19], v[64:65], v[80:81] op_sel_hi:[0,1,1] neg_lo:[1,0,0] neg_hi:[1,0,0]
    v_pk_fma_f32 v[98:99], v[18:19], v[66:67], v[82:83] op_sel_hi:[0,1,1] neg_lo:[1,0,0] neg_hi:[1,0,0]
    v_pk_fma_f32 v[100:101], v[18:19], v[68:69], v[84:85] op_sel_hi:[0,1,1] neg_lo:[1,0,0] neg_hi:[1,0,0]
    v_pk_fma_f32 v[102:103], v[18:19], v[70:71], v[86:87] op_sel_hi:[0,1,1] neg_lo:[1,0,0] neg_hi:[1,0,0]
    v_pk_fma_f32 v[192:193], v[18:19], v[192:193], v[96:97] op_sel:[1,0,0] op_sel_hi:[1,1,1]
    v_pk_fma_f32 v[194:195], v[18:19], v[194:195], v[98:99] op_sel:[1,0,0] op_sel_hi:[1,1,1]
    v_pk_fma_f32 v[196:197], v[18:19], v[196:197], v[100:101] op_sel:[1,0,0] op_sel_hi:[1,1,1]
    v_pk_fma_f32 v[198:199], v[18:19], v[198:199], v[102:103] op_sel:[1,0,0] op_sel_hi:[1,1,1]
    v_exp_f32 v96, v192
    v_exp_f32 v97, v193
    v_exp_f32 v98, v194
    v_exp_f32 v99, v195
    v_exp_f32 v100, v196
    v_exp_f32 v101, v197
    v_exp_f32 v102, v198
    v_exp_f32 v103, v199
    v_pk_add_f32 v[104:105], v[96:97], 2.0 op_sel_hi:[1,0]
    v_pk_add_f32 v[106:107], v[98:99], 2.0 op_sel_hi:[1,0]
    v_pk_add_f32 v[108:109], v[100:101], 2.0 op_sel_hi:[1,0]
    v_pk_add_f32 v[110:111], v[102:103], 2.0 op_sel_hi:[1,0]
    v_pk_fma_f32 v[96:97], v[96:97], v[104:105], 2.0 op_sel_hi:[1,1,0]
    v_pk_fma_f32 v[98:99], v[98:99], v[106:107], 2.0 op_sel_hi:[1,1,0]
    v_pk_fma_f32 v[100:101], v[100:101], v[108:109], 2.0 op_sel_hi:[1,1,0]
    v_pk_fma_f32 v[102:103], v[102:103], v[110:111], 2.0 op_sel_hi:[1,1,0]
    v_rcp_f32 v96, v96
    v_rcp_f32 v97, v97
    v_rcp_f32 v98, v98
    v_rcp_f32 v99, v99
    v_rcp_f32 v100, v100
    v_rcp_f32 v101, v101
    v_rcp_f32 v102, v102
    v_rcp_f32 v103, v103
    v_pk_fma_f32 v[96:97], v[96:97], s[80:81], v[24:25]
    v_pk_fma_f32 v[98:99], v[98:99], s[80:81], v[24:25]
    v_pk_fma_f32 v[100:101], v[100:101], s[80:81], v[24:25]
    v_pk_fma_f32 v[102:103], v[102:103], s[80:81], v[24:25]
    v_pk_mul_f32 v[96:97], v[96:97], v[192:193]
    v_pk_mul_f32 v[98:99], v[98:99], v[194:195]
    v_pk_mul_f32 v[100:101], v[100:101], v[196:197]
    v_pk_mul_f32 v[102:103], v[102:103], v[198:199]
    v_cvt_pk_bf16_f32 v192, v96, v97
    v_cvt_pk_bf16_f32 v193, v98, v99
    v_cvt_pk_bf16_f32 v194, v100, v101
    v_cvt_pk_bf16_f32 v195, v102, v103
    buffer_store_dwordx4 v[192:195], v22, s[56:59], s83 offen offset:2048 sc1
    v_pk_fma_f32 v[96:97], v[18:19], v[72:73], v[88:89] op_sel_hi:[0,1,1] neg_lo:[1,0,0] neg_hi:[1,0,0]
    v_pk_fma_f32 v[98:99], v[18:19], v[74:75], v[90:91] op_sel_hi:[0,1,1] neg_lo:[1,0,0] neg_hi:[1,0,0]
    v_pk_fma_f32 v[100:101], v[18:19], v[76:77], v[92:93] op_sel_hi:[0,1,1] neg_lo:[1,0,0] neg_hi:[1,0,0]
    v_pk_fma_f32 v[102:103], v[18:19], v[78:79], v[94:95] op_sel_hi:[0,1,1] neg_lo:[1,0,0] neg_hi:[1,0,0]
    v_pk_fma_f32 v[200:201], v[18:19], v[200:201], v[96:97] op_sel:[1,0,0] op_sel_hi:[1,1,1]
    v_pk_fma_f32 v[202:203], v[18:19], v[202:203], v[98:99] op_sel:[1,0,0] op_sel_hi:[1,1,1]
    v_pk_fma_f32 v[204:205], v[18:19], v[204:205], v[100:101] op_sel:[1,0,0] op_sel_hi:[1,1,1]
    v_pk_fma_f32 v[206:207], v[18:19], v[206:207], v[102:103] op_sel:[1,0,0] op_sel_hi:[1,1,1]
    v_exp_f32 v96, v200
    v_exp_f32 v97, v201
    v_exp_f32 v98, v202
    v_exp_f32 v99, v203
    v_exp_f32 v100, v204
    v_exp_f32 v101, v205
    v_exp_f32 v102, v206
    v_exp_f32 v103, v207
    v_pk_add_f32 v[104:105], v[96:97], 2.0 op_sel_hi:[1,0]
    v_pk_add_f32 v[106:107], v[98:99], 2.0 op_sel_hi:[1,0]
    v_pk_add_f32 v[108:109], v[100:101], 2.0 op_sel_hi:[1,0]
    v_pk_add_f32 v[110:111], v[102:103], 2.0 op_sel_hi:[1,0]
    v_pk_fma_f32 v[96:97], v[96:97], v[104:105], 2.0 op_sel_hi:[1,1,0]
    v_pk_fma_f32 v[98:99], v[98:99], v[106:107], 2.0 op_sel_hi:[1,1,0]
    v_pk_fma_f32 v[100:101], v[100:101], v[108:109], 2.0 op_sel_hi:[1,1,0]
    v_pk_fma_f32 v[102:103], v[102:103], v[110:111], 2.0 op_sel_hi:[1,1,0]
    v_rcp_f32 v96, v96
    v_rcp_f32 v97, v97
    v_rcp_f32 v98, v98
    v_rcp_f32 v99, v99
    v_rcp_f32 v100, v100
    v_rcp_f32 v101, v101
    v_rcp_f32 v102, v102
    v_rcp_f32 v103, v103
    v_pk_fma_f32 v[96:97], v[96:97], s[80:81], v[24:25]
    v_pk_fma_f32 v[98:99], v[98:99], s[80:81], v[24:25]
    v_pk_fma_f32 v[100:101], v[100:101], s[80:81], v[24:25]
    v_pk_fma_f32 v[102:103], v[102:103], s[80:81], v[24:25]
    v_pk_mul_f32 v[96:97], v[96:97], v[200:201]
    v_pk_mul_f32 v[98:99], v[98:99], v[202:203]
    v_pk_mul_f32 v[100:101], v[100:101], v[204:205]
    v_pk_mul_f32 v[102:103], v[102:103], v[206:207]
    v_cvt_pk_bf16_f32 v200, v96, v97
    v_cvt_pk_bf16_f32 v201, v98, v99
    v_cvt_pk_bf16_f32 v202, v100, v101
    v_cvt_pk_bf16_f32 v203, v102, v103
    buffer_store_dwordx4 v[200:203], v22, s[56:59], s83 offen offset:2560 sc1
    s_waitcnt lgkmcnt(0)
    v_pk_fma_f32 v[96:97], v[16:17], v[32:33], v[48:49] op_sel_hi:[0,1,1] neg_lo:[1,0,0] neg_hi:[1,0,0]
    v_pk_fma_f32 v[98:99], v[16:17], v[34:35], v[50:51] op_sel_hi:[0,1,1] neg_lo:[1,0,0] neg_hi:[1,0,0]
    v_pk_fma_f32 v[100:101], v[16:17], v[36:37], v[52:53] op_sel_hi:[0,1,1] neg_lo:[1,0,0] neg_hi:[1,0,0]
    v_pk_fma_f32 v[102:103], v[16:17], v[38:39], v[54:55] op_sel_hi:[0,1,1] neg_lo:[1,0,0] neg_hi:[1,0,0]
    v_pk_fma_f32 v[160:161], v[16:17], v[160:161], v[96:97] op_sel:[1,0,0] op_sel_hi:[1,1,1]
    v_pk_fma_f32 v[162:163], v[16:17], v[162:163], v[98:99] op_sel:[1,0,0] op_sel_hi:[1,1,1]
    v_pk_fma_f32 v[164:165], v[16:17], v[164:165], v[100:101] op_sel:[1,0,0] op_sel_hi:[1,1,1]
    v_pk_fma_f32 v[166:167], v[16:17], v[166:167], v[102:103] op_sel:[1,0,0] op_sel_hi:[1,1,1]
    v_exp_f32 v96, v160
    v_exp_f32 v97, v161
    v_exp_f32 v98, v162
    v_exp_f32 v99, v163
    v_exp_f32 v100, v164
    v_exp_f32 v101, v165
    v_exp_f32 v102, v166
    v_exp_f32 v103, v167
    v_pk_add_f32 v[104:105], v[96:97], 2.0 op_sel_hi:[1,0]
    v_pk_add_f32 v[106:107], v[98:99], 2.0 op_sel_hi:[1,0]
    v_pk_add_f32 v[108:109], v[100:101], 2.0 op_sel_hi:[1,0]
    v_pk_add_f32 v[110:111], v[102:103], 2.0 op_sel_hi:[1,0]
    v_pk_fma_f32 v[96:97], v[96:97], v[104:105], 2.0 op_sel_hi:[1,1,0]
    v_pk_fma_f32 v[98:99], v[98:99], v[106:107], 2.0 op_sel_hi:[1,1,0]
    v_pk_fma_f32 v[100:101], v[100:101], v[108:109], 2.0 op_sel_hi:[1,1,0]
    v_pk_fma_f32 v[102:103], v[102:103], v[110:111], 2.0 op_sel_hi:[1,1,0]
    v_rcp_f32 v96, v96
    v_rcp_f32 v97, v97
    v_rcp_f32 v98, v98
    v_rcp_f32 v99, v99
    v_rcp_f32 v100, v100
    v_rcp_f32 v101, v101
    v_rcp_f32 v102, v102
    v_rcp_f32 v103, v103
    v_pk_fma_f32 v[96:97], v[96:97], s[80:81], v[24:25]
    v_pk_fma_f32 v[98:99], v[98:99], s[80:81], v[24:25]
    v_pk_fma_f32 v[100:101], v[100:101], s[80:81], v[24:25]
    v_pk_fma_f32 v[102:103], v[102:103], s[80:81], v[24:25]
    v_pk_mul_f32 v[96:97], v[96:97], v[160:161]
    v_pk_mul_f32 v[98:99], v[98:99], v[162:163]
    v_pk_mul_f32 v[100:101], v[100:101], v[164:165]
    v_pk_mul_f32 v[102:103], v[102:103], v[166:167]
    v_cvt_pk_bf16_f32 v160, v96, v97
    v_cvt_pk_bf16_f32 v161, v98, v99
    v_cvt_pk_bf16_f32 v162, v100, v101
    v_cvt_pk_bf16_f32 v163, v102, v103
    buffer_store_dwordx4 v[160:163], v22, s[56:59], s84 offen offset:0 sc1
    v_pk_fma_f32 v[96:97], v[16:17], v[40:41], v[56:57] op_sel_hi:[0,1,1] neg_lo:[1,0,0] neg_hi:[1,0,0]
    v_pk_fma_f32 v[98:99], v[16:17], v[42:43], v[58:59] op_sel_hi:[0,1,1] neg_lo:[1,0,0] neg_hi:[1,0,0]
    v_pk_fma_f32 v[100:101], v[16:17], v[44:45], v[60:61] op_sel_hi:[0,1,1] neg_lo:[1,0,0] neg_hi:[1,0,0]
    v_pk_fma_f32 v[102:103], v[16:17], v[46:47], v[62:63] op_sel_hi:[0,1,1] neg_lo:[1,0,0] neg_hi:[1,0,0]
    v_pk_fma_f32 v[168:169], v[16:17], v[168:169], v[96:97] op_sel:[1,0,0] op_sel_hi:[1,1,1]
    v_pk_fma_f32 v[170:171], v[16:17], v[170:171], v[98:99] op_sel:[1,0,0] op_sel_hi:[1,1,1]
    v_pk_fma_f32 v[172:173], v[16:17], v[172:173], v[100:101] op_sel:[1,0,0] op_sel_hi:[1,1,1]
    v_pk_fma_f32 v[174:175], v[16:17], v[174:175], v[102:103] op_sel:[1,0,0] op_sel_hi:[1,1,1]
    v_exp_f32 v96, v168
    v_exp_f32 v97, v169
    v_exp_f32 v98, v170
    v_exp_f32 v99, v171
    v_exp_f32 v100, v172
    v_exp_f32 v101, v173
    v_exp_f32 v102, v174
    v_exp_f32 v103, v175
    v_pk_add_f32 v[104:105], v[96:97], 2.0 op_sel_hi:[1,0]
    v_pk_add_f32 v[106:107], v[98:99], 2.0 op_sel_hi:[1,0]
    v_pk_add_f32 v[108:109], v[100:101], 2.0 op_sel_hi:[1,0]
    v_pk_add_f32 v[110:111], v[102:103], 2.0 op_sel_hi:[1,0]
    v_pk_fma_f32 v[96:97], v[96:97], v[104:105], 2.0 op_sel_hi:[1,1,0]
    v_pk_fma_f32 v[98:99], v[98:99], v[106:107], 2.0 op_sel_hi:[1,1,0]
    v_pk_fma_f32 v[100:101], v[100:101], v[108:109], 2.0 op_sel_hi:[1,1,0]
    v_pk_fma_f32 v[102:103], v[102:103], v[110:111], 2.0 op_sel_hi:[1,1,0]
    v_rcp_f32 v96, v96
    v_rcp_f32 v97, v97
    v_rcp_f32 v98, v98
    v_rcp_f32 v99, v99
    v_rcp_f32 v100, v100
    v_rcp_f32 v101, v101
    v_rcp_f32 v102, v102
    v_rcp_f32 v103, v103
    v_pk_fma_f32 v[96:97], v[96:97], s[80:81], v[24:25]
    v_pk_fma_f32 v[98:99], v[98:99], s[80:81], v[24:25]
    v_pk_fma_f32 v[100:101], v[100:101], s[80:81], v[24:25]
    v_pk_fma_f32 v[102:103], v[102:103], s[80:81], v[24:25]
    v_pk_mul_f32 v[96:97], v[96:97], v[168:169]
    v_pk_mul_f32 v[98:99], v[98:99], v[170:171]
    v_pk_mul_f32 v[100:101], v[100:101], v[172:173]
    v_pk_mul_f32 v[102:103], v[102:103], v[174:175]
    v_cvt_pk_bf16_f32 v168, v96, v97
    v_cvt_pk_bf16_f32 v169, v98, v99
    v_cvt_pk_bf16_f32 v170, v100, v101
    v_cvt_pk_bf16_f32 v171, v102, v103
    buffer_store_dwordx4 v[168:171], v22, s[56:59], s84 offen offset:512 sc1
    v_pk_fma_f32 v[96:97], v[18:19], v[32:33], v[48:49] op_sel_hi:[0,1,1] neg_lo:[1,0,0] neg_hi:[1,0,0]
    v_pk_fma_f32 v[98:99], v[18:19], v[34:35], v[50:51] op_sel_hi:[0,1,1] neg_lo:[1,0,0] neg_hi:[1,0,0]
    v_pk_fma_f32 v[100:101], v[18:19], v[36:37], v[52:53] op_sel_hi:[0,1,1] neg_lo:[1,0,0] neg_hi:[1,0,0]
    v_pk_fma_f32 v[102:103], v[18:19], v[38:39], v[54:55] op_sel_hi:[0,1,1] neg_lo:[1,0,0] neg_hi:[1,0,0]
    v_pk_fma_f32 v[208:209], v[18:19], v[208:209], v[96:97] op_sel:[1,0,0] op_sel_hi:[1,1,1]
    v_pk_fma_f32 v[210:211], v[18:19], v[210:211], v[98:99] op_sel:[1,0,0] op_sel_hi:[1,1,1]
    v_pk_fma_f32 v[212:213], v[18:19], v[212:213], v[100:101] op_sel:[1,0,0] op_sel_hi:[1,1,1]
    v_pk_fma_f32 v[214:215], v[18:19], v[214:215], v[102:103] op_sel:[1,0,0] op_sel_hi:[1,1,1]
    v_exp_f32 v96, v208
    v_exp_f32 v97, v209
    v_exp_f32 v98, v210
    v_exp_f32 v99, v211
    v_exp_f32 v100, v212
    v_exp_f32 v101, v213
    v_exp_f32 v102, v214
    v_exp_f32 v103, v215
    v_pk_add_f32 v[104:105], v[96:97], 2.0 op_sel_hi:[1,0]
    v_pk_add_f32 v[106:107], v[98:99], 2.0 op_sel_hi:[1,0]
    v_pk_add_f32 v[108:109], v[100:101], 2.0 op_sel_hi:[1,0]
    v_pk_add_f32 v[110:111], v[102:103], 2.0 op_sel_hi:[1,0]
    v_pk_fma_f32 v[96:97], v[96:97], v[104:105], 2.0 op_sel_hi:[1,1,0]
    v_pk_fma_f32 v[98:99], v[98:99], v[106:107], 2.0 op_sel_hi:[1,1,0]
    v_pk_fma_f32 v[100:101], v[100:101], v[108:109], 2.0 op_sel_hi:[1,1,0]
    v_pk_fma_f32 v[102:103], v[102:103], v[110:111], 2.0 op_sel_hi:[1,1,0]
    v_rcp_f32 v96, v96
    v_rcp_f32 v97, v97
    v_rcp_f32 v98, v98
    v_rcp_f32 v99, v99
    v_rcp_f32 v100, v100
    v_rcp_f32 v101, v101
    v_rcp_f32 v102, v102
    v_rcp_f32 v103, v103
    v_pk_fma_f32 v[96:97], v[96:97], s[80:81], v[24:25]
    v_pk_fma_f32 v[98:99], v[98:99], s[80:81], v[24:25]
    v_pk_fma_f32 v[100:101], v[100:101], s[80:81], v[24:25]
    v_pk_fma_f32 v[102:103], v[102:103], s[80:81], v[24:25]
    v_pk_mul_f32 v[96:97], v[96:97], v[208:209]
    v_pk_mul_f32 v[98:99], v[98:99], v[210:211]
    v_pk_mul_f32 v[100:101], v[100:101], v[212:213]
    v_pk_mul_f32 v[102:103], v[102:103], v[214:215]
    v_cvt_pk_bf16_f32 v208, v96, v97
    v_cvt_pk_bf16_f32 v209, v98, v99
    v_cvt_pk_bf16_f32 v210, v100, v101
    v_cvt_pk_bf16_f32 v211, v102, v103
    buffer_store_dwordx4 v[208:211], v22, s[56:59], s84 offen offset:2048 sc1
    v_pk_fma_f32 v[96:97], v[18:19], v[40:41], v[56:57] op_sel_hi:[0,1,1] neg_lo:[1,0,0] neg_hi:[1,0,0]
    v_pk_fma_f32 v[98:99], v[18:19], v[42:43], v[58:59] op_sel_hi:[0,1,1] neg_lo:[1,0,0] neg_hi:[1,0,0]
    v_pk_fma_f32 v[100:101], v[18:19], v[44:45], v[60:61] op_sel_hi:[0,1,1] neg_lo:[1,0,0] neg_hi:[1,0,0]
    v_pk_fma_f32 v[102:103], v[18:19], v[46:47], v[62:63] op_sel_hi:[0,1,1] neg_lo:[1,0,0] neg_hi:[1,0,0]
    v_pk_fma_f32 v[216:217], v[18:19], v[216:217], v[96:97] op_sel:[1,0,0] op_sel_hi:[1,1,1]
    v_pk_fma_f32 v[218:219], v[18:19], v[218:219], v[98:99] op_sel:[1,0,0] op_sel_hi:[1,1,1]
    v_pk_fma_f32 v[220:221], v[18:19], v[220:221], v[100:101] op_sel:[1,0,0] op_sel_hi:[1,1,1]
    v_pk_fma_f32 v[222:223], v[18:19], v[222:223], v[102:103] op_sel:[1,0,0] op_sel_hi:[1,1,1]
    v_exp_f32 v96, v216
    v_exp_f32 v97, v217
    v_exp_f32 v98, v218
    v_exp_f32 v99, v219
    v_exp_f32 v100, v220
    v_exp_f32 v101, v221
    v_exp_f32 v102, v222
    v_exp_f32 v103, v223
    v_pk_add_f32 v[104:105], v[96:97], 2.0 op_sel_hi:[1,0]
    v_pk_add_f32 v[106:107], v[98:99], 2.0 op_sel_hi:[1,0]
    v_pk_add_f32 v[108:109], v[100:101], 2.0 op_sel_hi:[1,0]
    v_pk_add_f32 v[110:111], v[102:103], 2.0 op_sel_hi:[1,0]
    v_pk_fma_f32 v[96:97], v[96:97], v[104:105], 2.0 op_sel_hi:[1,1,0]
    v_pk_fma_f32 v[98:99], v[98:99], v[106:107], 2.0 op_sel_hi:[1,1,0]
    v_pk_fma_f32 v[100:101], v[100:101], v[108:109], 2.0 op_sel_hi:[1,1,0]
    v_pk_fma_f32 v[102:103], v[102:103], v[110:111], 2.0 op_sel_hi:[1,1,0]
    v_rcp_f32 v96, v96
    v_rcp_f32 v97, v97
    v_rcp_f32 v98, v98
    v_rcp_f32 v99, v99
    v_rcp_f32 v100, v100
    v_rcp_f32 v101, v101
    v_rcp_f32 v102, v102
    v_rcp_f32 v103, v103
    v_pk_fma_f32 v[96:97], v[96:97], s[80:81], v[24:25]
    v_pk_fma_f32 v[98:99], v[98:99], s[80:81], v[24:25]
    v_pk_fma_f32 v[100:101], v[100:101], s[80:81], v[24:25]
    v_pk_fma_f32 v[102:103], v[102:103], s[80:81], v[24:25]
    v_pk_mul_f32 v[96:97], v[96:97], v[216:217]
    v_pk_mul_f32 v[98:99], v[98:99], v[218:219]
    v_pk_mul_f32 v[100:101], v[100:101], v[220:221]
    v_pk_mul_f32 v[102:103], v[102:103], v[222:223]
    v_cvt_pk_bf16_f32 v216, v96, v97
    v_cvt_pk_bf16_f32 v217, v98, v99
    v_cvt_pk_bf16_f32 v218, v100, v101
    v_cvt_pk_bf16_f32 v219, v102, v103
    buffer_store_dwordx4 v[216:219], v22, s[56:59], s84 offen offset:2560 sc1
    s_branch K_cpub
K_ssm:
    s_lshl_b32 s77, s38, 12
    v_xor_b32 v12, 0, v5
    v_add_u32 v8, s77, v12
    v_add_u32 v12, 16384, v12
    v_xor_b32 v13, 32, v5
    v_add_u32 v9, s77, v13
    v_add_u32 v13, 16384, v13
    v_xor_b32 v14, 64, v5
    v_add_u32 v10, s77, v14
    v_add_u32 v14, 16384, v14
    v_xor_b32 v15, 96, v5
    v_add_u32 v11, s77, v15
    v_add_u32 v15, 16384, v15
    s_barrier
    ds_read_b128 v[64:67], v8
    ds_read_b128 v[68:71], v12 offset:0
    ds_read_b128 v[72:75], v12 offset:4096
    ds_read_b128 v[76:79], v12 offset:8192
    ds_read_b128 v[80:83], v12 offset:12288
    ds_read_b128 v[84:87], v12 offset:16384
    ds_read_b128 v[88:91], v12 offset:20480
K_ssm_loop:
    s_add_u32 s72, s72, 1
    s_cmp_eq_u32 s72, 3
    s_cselect_b32 s72, 0, s72
    s_cselect_b32 s74, 4294885376, s94
    s_waitcnt lgkmcnt(5)
    v_mfma_f32_32x32x16_bf16 v[128:143], v[64:67], v[68:71], v[128:143]
    ds_read_b128 v[92:95], v9
    ds_read_b128 v[96:99], v13 offset:0
    s_waitcnt lgkmcnt(6)
    v_mfma_f32_32x32x16_bf16 v[144:159], v[64:67], v[72:75], v[144:159]
    ds_read_b128 v[100:103], v13 offset:4096
    ds_read_b128 v[104:107], v13 offset:8192
    s_waitcnt lgkmcnt(7)
    v_mfma_f32_32x32x16_bf16 v[160:175], v[64:67], v[76:79], v[160:175]
    ds_read_b128 v[108:111], v13 offset:12288
    ds_read_b128 v[112:115], v13 offset:16384
    s_waitcnt lgkmcnt(8)
    v_mfma_f32_32x32x16_bf16 v[176:191], v[64:67], v[80:83], v[176:191]
    ds_read_b128 v[116:119], v13 offset:20480
    s_waitcnt lgkmcnt(8)
    v_mfma_f32_32x32x16_bf16 v[192:207], v[64:67], v[84:87], v[192:207]
    s_waitcnt lgkmcnt(7)
    v_mfma_f32_32x32x16_bf16 v[208:223], v[64:67], v[88:91], v[208:223]
    s_waitcnt lgkmcnt(5)
    v_mfma_f32_32x32x16_bf16 v[128:143], v[92:95], v[96:99], v[128:143]
    ds_read_b128 v[64:67], v10
    ds_read_b128 v[68:71], v14 offset:0
    s_waitcnt lgkmcnt(6)
    v_mfma_f32_32x32x16_bf16 v[144:159], v[92:95], v[100:103], v[144:159]
    ds_read_b128 v[72:75], v14 offset:4096
    ds_read_b128 v[76:79], v14 offset:8192
    s_waitcnt lgkmcnt(7)
    v_mfma_f32_32x32x16_bf16 v[160:175], v[92:95], v[104:107], v[160:175]
    ds_read_b128 v[80:83], v14 offset:12288
    ds_read_b128 v[84:87], v14 offset:16384
    s_waitcnt lgkmcnt(8)
    v_mfma_f32_32x32x16_bf16 v[176:191], v[92:95], v[108:111], v[176:191]
    ds_read_b128 v[88:91], v14 offset:20480
    s_waitcnt lgkmcnt(8)
    v_mfma_f32_32x32x16_bf16 v[192:207], v[92:95], v[112:115], v[192:207]
    s_waitcnt lgkmcnt(7)
    v_mfma_f32_32x32x16_bf16 v[208:223], v[92:95], v[116:119], v[208:223]
    s_waitcnt lgkmcnt(5)
    v_mfma_f32_32x32x16_bf16 v[128:143], v[64:67], v[68:71], v[128:143]
    ds_read_b128 v[92:95], v11
    ds_read_b128 v[96:99], v15 offset:0
    s_waitcnt lgkmcnt(6)
    v_mfma_f32_32x32x16_bf16 v[144:159], v[64:67], v[72:75], v[144:159]
    ds_read_b128 v[100:103], v15 offset:4096
    ds_read_b128 v[104:107], v15 offset:8192
    s_waitcnt lgkmcnt(7)
    v_mfma_f32_32x32x16_bf16 v[160:175], v[64:67], v[76:79], v[160:175]
    ds_read_b128 v[108:111], v15 offset:12288
    ds_read_b128 v[112:115], v15 offset:16384
    s_waitcnt lgkmcnt(8)
    v_mfma_f32_32x32x16_bf16 v[176:191], v[64:67], v[80:83], v[176:191]
    ds_read_b128 v[116:119], v15 offset:20480
    s_waitcnt lgkmcnt(8)
    v_mfma_f32_32x32x16_bf16 v[192:207], v[64:67], v[84:87], v[192:207]
    v_add_u32 v8, s74, v8
    v_add_u32 v9, s74, v9
    v_add_u32 v10, s74, v10
    v_add_u32 v11, s74, v11
    s_waitcnt lgkmcnt(7)
    v_mfma_f32_32x32x16_bf16 v[208:223], v[64:67], v[88:91], v[208:223]
    s_waitcnt lgkmcnt(5)
    v_mfma_f32_32x32x16_bf16 v[128:143], v[92:95], v[96:99], v[128:143]
    v_add_u32 v12, s74, v12
    v_add_u32 v13, s74, v13
    v_add_u32 v14, s74, v14
    v_add_u32 v15, s74, v15
    s_waitcnt lgkmcnt(0)
    s_barrier
    v_mfma_f32_32x32x16_bf16 v[144:159], v[92:95], v[100:103], v[144:159]
    ds_read_b128 v[64:67], v8
    ds_read_b128 v[68:71], v12 offset:0
    v_mfma_f32_32x32x16_bf16 v[160:175], v[92:95], v[104:107], v[160:175]
    ds_read_b128 v[72:75], v12 offset:4096
    ds_read_b128 v[76:79], v12 offset:8192
    ds_read_b128 v[80:83], v12 offset:12288
    v_mfma_f32_32x32x16_bf16 v[176:191], v[92:95], v[108:111], v[176:191]
    ds_read_b128 v[84:87], v12 offset:16384
    ds_read_b128 v[88:91], v12 offset:20480
    v_mfma_f32_32x32x16_bf16 v[192:207], v[92:95], v[112:115], v[192:207]
    v_mfma_f32_32x32x16_bf16 v[208:223], v[92:95], v[116:119], v[208:223]
    s_sub_u32 s73, s73, 1
    s_cmp_lg_u32 s73, 0
    s_cbranch_scc1 K_ssm_loop
    s_setprio 3
    s_waitcnt vmcnt(0) lgkmcnt(0)
    s_barrier
    s_lshl_b32 s77, s38, 7
    s_add_u32 s77, s77, 143360
    v_lshl_add_u32 v8, v4, 4, s77
    v_lshlrev_b32 v9, 5, v3
    v_add_u32 v9, 144384, v9
    ds_read_b128 v[48:51], v9 offset:0
    ds_read_b128 v[52:55], v9 offset:16
    ds_read_b128 v[56:59], v9 offset:1024
    ds_read_b128 v[60:63], v9 offset:1040
    ds_read_b128 v[64:67], v9 offset:2048
    ds_read_b128 v[68:71], v9 offset:2064
    ds_read_b128 v[16:19], v8 offset:0
    ds_read_b128 v[32:35], v8 offset:512
    ds_read_b128 v[20:23], v8 offset:32
    ds_read_b128 v[36:39], v8 offset:544
    ds_read_b128 v[24:27], v8 offset:64
    ds_read_b128 v[40:43], v8 offset:576
    ds_read_b128 v[28:31], v8 offset:96
    ds_read_b128 v[44:47], v8 offset:608
    s_mul_i32 s77, s38, 1536
    s_add_u32 s77, s77, 148480
    v_mul_u32_u24 v10, 768, v4
    v_lshl_add_u32 v10, v3, 3, v10
    v_add_u32 v10, s77, v10
    s_waitcnt lgkmcnt(6)
    v_pk_fma_f32 v[128:129], v[54:55], v[16:17], v[128:129] op_sel:[0,0,0] op_sel_hi:[0,1,1] neg_lo:[1,0,0] neg_hi:[1,0,0]
    v_pk_fma_f32 v[160:161], v[62:63], v[16:17], v[160:161] op_sel:[0,0,0] op_sel_hi:[0,1,1] neg_lo:[1,0,0] neg_hi:[1,0,0]
    v_pk_fma_f32 v[192:193], v[70:71], v[16:17], v[192:193] op_sel:[0,0,0] op_sel_hi:[0,1,1] neg_lo:[1,0,0] neg_hi:[1,0,0]
    v_pk_fma_f32 v[144:145], v[54:55], v[16:17], v[144:145] op_sel:[1,0,0] op_sel_hi:[1,1,1] neg_lo:[1,0,0] neg_hi:[1,0,0]
    v_pk_fma_f32 v[176:177], v[62:63], v[16:17], v[176:177] op_sel:[1,0,0] op_sel_hi:[1,1,1] neg_lo:[1,0,0] neg_hi:[1,0,0]
    v_pk_fma_f32 v[208:209], v[70:71], v[16:17], v[208:209] op_sel:[1,0,0] op_sel_hi:[1,1,1] neg_lo:[1,0,0] neg_hi:[1,0,0]
    v_pk_mul_f32 v[128:129], v[32:33], v[128:129]
    v_pk_mul_f32 v[160:161], v[32:33], v[160:161]
    v_pk_mul_f32 v[192:193], v[32:33], v[192:193]
    v_pk_mul_f32 v[144:145], v[32:33], v[144:145]
    v_pk_mul_f32 v[176:177], v[32:33], v[176:177]
    v_pk_mul_f32 v[208:209], v[32:33], v[208:209]
    v_pk_fma_f32 v[130:131], v[54:55], v[18:19], v[130:131] op_sel:[0,0,0] op_sel_hi:[0,1,1] neg_lo:[1,0,0] neg_hi:[1,0,0]
    v_pk_fma_f32 v[162:163], v[62:63], v[18:19], v[162:163] op_sel:[0,0,0] op_sel_hi:[0,1,1] neg_lo:[1,0,0] neg_hi:[1,0,0]
    v_pk_fma_f32 v[194:195], v[70:71], v[18:19], v[194:195] op_sel:[0,0,0] op_sel_hi:[0,1,1] neg_lo:[1,0,0] neg_hi:[1,0,0]
    v_pk_fma_f32 v[146:147], v[54:55], v[18:19], v[146:147] op_sel:[1,0,0] op_sel_hi:[1,1,1] neg_lo:[1,0,0] neg_hi:[1,0,0]
    v_pk_fma_f32 v[178:179], v[62:63], v[18:19], v[178:179] op_sel:[1,0,0] op_sel_hi:[1,1,1] neg_lo:[1,0,0] neg_hi:[1,0,0]
    v_pk_fma_f32 v[210:211], v[70:71], v[18:19], v[210:211] op_sel:[1,0,0] op_sel_hi:[1,1,1] neg_lo:[1,0,0] neg_hi:[1,0,0]
    v_pk_mul_f32 v[130:131], v[34:35], v[130:131]
    v_pk_mul_f32 v[162:163], v[34:35], v[162:163]
    v_pk_mul_f32 v[194:195], v[34:35], v[194:195]
    v_pk_mul_f32 v[146:147], v[34:35], v[146:147]
    v_pk_mul_f32 v[178:179], v[34:35], v[178:179]
    v_pk_mul_f32 v[210:211], v[34:35], v[210:211]
    v_pk_fma_f32 v[88:89], v[48:49], v[128:129], v[130:131] op_sel:[0,0,0] op_sel_hi:[0,1,1]
    v_pk_fma_f32 v[96:97], v[56:57], v[160:161], v[162:163] op_sel:[0,0,0] op_sel_hi:[0,1,1]
    v_pk_fma_f32 v[104:105], v[64:65], v[192:193], v[194:195] op_sel:[0,0,0] op_sel_hi:[0,1,1]
    v_pk_fma_f32 v[90:91], v[48:49], v[144:145], v[146:147] op_sel:[0,0,0] op_sel_hi:[0,1,1]
    v_pk_fma_f32 v[98:99], v[56:57], v[176:177], v[178:179] op_sel:[0,0,0] op_sel_hi:[0,1,1]
    v_pk_fma_f32 v[106:107], v[64:65], v[208:209], v[210:211] op_sel:[0,0,0] op_sel_hi:[0,1,1]
    v_pk_fma_f32 v[88:89], v[48:49], v[144:145], v[88:89] op_sel:[1,0,0] op_sel_hi:[1,1,1] neg_lo:[1,0,0] neg_hi:[1,0,0]
    v_pk_fma_f32 v[96:97], v[56:57], v[176:177], v[96:97] op_sel:[1,0,0] op_sel_hi:[1,1,1] neg_lo:[1,0,0] neg_hi:[1,0,0]
    v_pk_fma_f32 v[104:105], v[64:65], v[208:209], v[104:105] op_sel:[1,0,0] op_sel_hi:[1,1,1] neg_lo:[1,0,0] neg_hi:[1,0,0]
    v_pk_fma_f32 v[90:91], v[48:49], v[128:129], v[90:91] op_sel:[1,0,0] op_sel_hi:[1,1,1]
    v_pk_fma_f32 v[98:99], v[56:57], v[160:161], v[98:99] op_sel:[1,0,0] op_sel_hi:[1,1,1]
    v_pk_fma_f32 v[106:107], v[64:65], v[192:193], v[106:107] op_sel:[1,0,0] op_sel_hi:[1,1,1]
    s_waitcnt lgkmcnt(4)
    v_pk_fma_f32 v[132:133], v[54:55], v[20:21], v[132:133] op_sel:[0,0,0] op_sel_hi:[0,1,1] neg_lo:[1,0,0] neg_hi:[1,0,0]
    v_pk_fma_f32 v[164:165], v[62:63], v[20:21], v[164:165] op_sel:[0,0,0] op_sel_hi:[0,1,1] neg_lo:[1,0,0] neg_hi:[1,0,0]
    v_pk_fma_f32 v[196:197], v[70:71], v[20:21], v[196:197] op_sel:[0,0,0] op_sel_hi:[0,1,1] neg_lo:[1,0,0] neg_hi:[1,0,0]
    v_pk_fma_f32 v[148:149], v[54:55], v[20:21], v[148:149] op_sel:[1,0,0] op_sel_hi:[1,1,1] neg_lo:[1,0,0] neg_hi:[1,0,0]
    v_pk_fma_f32 v[180:181], v[62:63], v[20:21], v[180:181] op_sel:[1,0,0] op_sel_hi:[1,1,1] neg_lo:[1,0,0] neg_hi:[1,0,0]
    v_pk_fma_f32 v[212:213], v[70:71], v[20:21], v[212:213] op_sel:[1,0,0] op_sel_hi:[1,1,1] neg_lo:[1,0,0] neg_hi:[1,0,0]
    v_pk_mul_f32 v[132:133], v[36:37], v[132:133]
    v_pk_mul_f32 v[164:165], v[36:37], v[164:165]
    v_pk_mul_f32 v[196:197], v[36:37], v[196:197]
    v_pk_mul_f32 v[148:149], v[36:37], v[148:149]
    v_pk_mul_f32 v[180:181], v[36:37], v[180:181]
    v_pk_mul_f32 v[212:213], v[36:37], v[212:213]
    v_pk_fma_f32 v[84:85], v[48:49], v[88:89], v[132:133] op_sel:[0,0,0] op_sel_hi:[0,1,1]
    v_pk_fma_f32 v[92:93], v[56:57], v[96:97], v[164:165] op_sel:[0,0,0] op_sel_hi:[0,1,1]
    v_pk_fma_f32 v[100:101], v[64:65], v[104:105], v[196:197] op_sel:[0,0,0] op_sel_hi:[0,1,1]
    v_pk_fma_f32 v[86:87], v[48:49], v[90:91], v[148:149] op_sel:[0,0,0] op_sel_hi:[0,1,1]
    v_pk_fma_f32 v[94:95], v[56:57], v[98:99], v[180:181] op_sel:[0,0,0] op_sel_hi:[0,1,1]
    v_pk_fma_f32 v[102:103], v[64:65], v[106:107], v[212:213] op_sel:[0,0,0] op_sel_hi:[0,1,1]
    v_pk_fma_f32 v[84:85], v[48:49], v[90:91], v[84:85] op_sel:[1,0,0] op_sel_hi:[1,1,1] neg_lo:[1,0,0] neg_hi:[1,0,0]
    v_pk_fma_f32 v[92:93], v[56:57], v[98:99], v[92:93] op_sel:[1,0,0] op_sel_hi:[1,1,1] neg_lo:[1,0,0] neg_hi:[1,0,0]
    v_pk_fma_f32 v[100:101], v[64:65], v[106:107], v[100:101] op_sel:[1,0,0] op_sel_hi:[1,1,1] neg_lo:[1,0,0] neg_hi:[1,0,0]
    v_pk_fma_f32 v[86:87], v[48:49], v[88:89], v[86:87] op_sel:[1,0,0] op_sel_hi:[1,1,1]
    v_pk_fma_f32 v[94:95], v[56:57], v[96:97], v[94:95] op_sel:[1,0,0] op_sel_hi:[1,1,1]
    v_pk_fma_f32 v[102:103], v[64:65], v[104:105], v[102:103] op_sel:[1,0,0] op_sel_hi:[1,1,1]
    v_pk_fma_f32 v[134:135], v[54:55], v[22:23], v[134:135] op_sel:[0,0,0] op_sel_hi:[0,1,1] neg_lo:[1,0,0] neg_hi:[1,0,0]
    v_pk_fma_f32 v[166:167], v[62:63], v[22:23], v[166:167] op_sel:[0,0,0] op_sel_hi:[0,1,1] neg_lo:[1,0,0] neg_hi:[1,0,0]
    v_pk_fma_f32 v[198:199], v[70:71], v[22:23], v[198:199] op_sel:[0,0,0] op_sel_hi:[0,1,1] neg_lo:[1,0,0] neg_hi:[1,0,0]
    v_pk_fma_f32 v[150:151], v[54:55], v[22:23], v[150:151] op_sel:[1,0,0] op_sel_hi:[1,1,1] neg_lo:[1,0,0] neg_hi:[1,0,0]
    v_pk_fma_f32 v[182:183], v[62:63], v[22:23], v[182:183] op_sel:[1,0,0] op_sel_hi:[1,1,1] neg_lo:[1,0,0] neg_hi:[1,0,0]
    v_pk_fma_f32 v[214:215], v[70:71], v[22:23], v[214:215] op_sel:[1,0,0] op_sel_hi:[1,1,1] neg_lo:[1,0,0] neg_hi:[1,0,0]
    v_pk_mul_f32 v[134:135], v[38:39], v[134:135]
    v_pk_mul_f32 v[166:167], v[38:39], v[166:167]
    v_pk_mul_f32 v[198:199], v[38:39], v[198:199]
    v_pk_mul_f32 v[150:151], v[38:39], v[150:151]
    v_pk_mul_f32 v[182:183], v[38:39], v[182:183]
    v_pk_mul_f32 v[214:215], v[38:39], v[214:215]
    v_pk_fma_f32 v[88:89], v[48:49], v[84:85], v[134:135] op_sel:[0,0,0] op_sel_hi:[0,1,1]
    v_pk_fma_f32 v[96:97], v[56:57], v[92:93], v[166:167] op_sel:[0,0,0] op_sel_hi:[0,1,1]
    v_pk_fma_f32 v[104:105], v[64:65], v[100:101], v[198:199] op_sel:[0,0,0] op_sel_hi:[0,1,1]
    v_pk_fma_f32 v[90:91], v[48:49], v[86:87], v[150:151] op_sel:[0,0,0] op_sel_hi:[0,1,1]
    v_pk_fma_f32 v[98:99], v[56:57], v[94:95], v[182:183] op_sel:[0,0,0] op_sel_hi:[0,1,1]
    v_pk_fma_f32 v[106:107], v[64:65], v[102:103], v[214:215] op_sel:[0,0,0] op_sel_hi:[0,1,1]
    v_pk_fma_f32 v[88:89], v[48:49], v[86:87], v[88:89] op_sel:[1,0,0] op_sel_hi:[1,1,1] neg_lo:[1,0,0] neg_hi:[1,0,0]
    v_pk_fma_f32 v[96:97], v[56:57], v[94:95], v[96:97] op_sel:[1,0,0] op_sel_hi:[1,1,1] neg_lo:[1,0,0] neg_hi:[1,0,0]
    v_pk_fma_f32 v[104:105], v[64:65], v[102:103], v[104:105] op_sel:[1,0,0] op_sel_hi:[1,1,1] neg_lo:[1,0,0] neg_hi:[1,0,0]
    v_pk_fma_f32 v[90:91], v[48:49], v[84:85], v[90:91] op_sel:[1,0,0] op_sel_hi:[1,1,1]
    v_pk_fma_f32 v[98:99], v[56:57], v[92:93], v[98:99] op_sel:[1,0,0] op_sel_hi:[1,1,1]
    v_pk_fma_f32 v[106:107], v[64:65], v[100:101], v[106:107] op_sel:[1,0,0] op_sel_hi:[1,1,1]
    s_waitcnt lgkmcnt(2)
    v_pk_fma_f32 v[136:137], v[54:55], v[24:25], v[136:137] op_sel:[0,0,0] op_sel_hi:[0,1,1] neg_lo:[1,0,0] neg_hi:[1,0,0]
    v_pk_fma_f32 v[168:169], v[62:63], v[24:25], v[168:169] op_sel:[0,0,0] op_sel_hi:[0,1,1] neg_lo:[1,0,0] neg_hi:[1,0,0]
    v_pk_fma_f32 v[200:201], v[70:71], v[24:25], v[200:201] op_sel:[0,0,0] op_sel_hi:[0,1,1] neg_lo:[1,0,0] neg_hi:[1,0,0]
    v_pk_fma_f32 v[152:153], v[54:55], v[24:25], v[152:153] op_sel:[1,0,0] op_sel_hi:[1,1,1] neg_lo:[1,0,0] neg_hi:[1,0,0]
    v_pk_fma_f32 v[184:185], v[62:63], v[24:25], v[184:185] op_sel:[1,0,0] op_sel_hi:[1,1,1] neg_lo:[1,0,0] neg_hi:[1,0,0]
    v_pk_fma_f32 v[216:217], v[70:71], v[24:25], v[216:217] op_sel:[1,0,0] op_sel_hi:[1,1,1] neg_lo:[1,0,0] neg_hi:[1,0,0]
    v_pk_mul_f32 v[136:137], v[40:41], v[136:137]
    v_pk_mul_f32 v[168:169], v[40:41], v[168:169]
    v_pk_mul_f32 v[200:201], v[40:41], v[200:201]
    v_pk_mul_f32 v[152:153], v[40:41], v[152:153]
    v_pk_mul_f32 v[184:185], v[40:41], v[184:185]
    v_pk_mul_f32 v[216:217], v[40:41], v[216:217]
    v_pk_fma_f32 v[84:85], v[48:49], v[88:89], v[136:137] op_sel:[0,0,0] op_sel_hi:[0,1,1]
    v_pk_fma_f32 v[92:93], v[56:57], v[96:97], v[168:169] op_sel:[0,0,0] op_sel_hi:[0,1,1]
    v_pk_fma_f32 v[100:101], v[64:65], v[104:105], v[200:201] op_sel:[0,0,0] op_sel_hi:[0,1,1]
    v_pk_fma_f32 v[86:87], v[48:49], v[90:91], v[152:153] op_sel:[0,0,0] op_sel_hi:[0,1,1]
    v_pk_fma_f32 v[94:95], v[56:57], v[98:99], v[184:185] op_sel:[0,0,0] op_sel_hi:[0,1,1]
    v_pk_fma_f32 v[102:103], v[64:65], v[106:107], v[216:217] op_sel:[0,0,0] op_sel_hi:[0,1,1]
    v_pk_fma_f32 v[84:85], v[48:49], v[90:91], v[84:85] op_sel:[1,0,0] op_sel_hi:[1,1,1] neg_lo:[1,0,0] neg_hi:[1,0,0]
    v_pk_fma_f32 v[92:93], v[56:57], v[98:99], v[92:93] op_sel:[1,0,0] op_sel_hi:[1,1,1] neg_lo:[1,0,0] neg_hi:[1,0,0]
    v_pk_fma_f32 v[100:101], v[64:65], v[106:107], v[100:101] op_sel:[1,0,0] op_sel_hi:[1,1,1] neg_lo:[1,0,0] neg_hi:[1,0,0]
    v_pk_fma_f32 v[86:87], v[48:49], v[88:89], v[86:87] op_sel:[1,0,0] op_sel_hi:[1,1,1]
    v_pk_fma_f32 v[94:95], v[56:57], v[96:97], v[94:95] op_sel:[1,0,0] op_sel_hi:[1,1,1]
    v_pk_fma_f32 v[102:103], v[64:65], v[104:105], v[102:103] op_sel:[1,0,0] op_sel_hi:[1,1,1]
    v_pk_fma_f32 v[138:139], v[54:55], v[26:27], v[138:139] op_sel:[0,0,0] op_sel_hi:[0,1,1] neg_lo:[1,0,0] neg_hi:[1,0,0]
    v_pk_fma_f32 v[170:171], v[62:63], v[26:27], v[170:171] op_sel:[0,0,0] op_sel_hi:[0,1,1] neg_lo:[1,0,0] neg_hi:[1,0,0]
    v_pk_fma_f32 v[202:203], v[70:71], v[26:27], v[202:203] op_sel:[0,0,0] op_sel_hi:[0,1,1] neg_lo:[1,0,0] neg_hi:[1,0,0]
    v_pk_fma_f32 v[154:155], v[54:55], v[26:27], v[154:155] op_sel:[1,0,0] op_sel_hi:[1,1,1] neg_lo:[1,0,0] neg_hi:[1,0,0]
    v_pk_fma_f32 v[186:187], v[62:63], v[26:27], v[186:187] op_sel:[1,0,0] op_sel_hi:[1,1,1] neg_lo:[1,0,0] neg_hi:[1,0,0]
    v_pk_fma_f32 v[218:219], v[70:71], v[26:27], v[218:219] op_sel:[1,0,0] op_sel_hi:[1,1,1] neg_lo:[1,0,0] neg_hi:[1,0,0]
    v_pk_mul_f32 v[138:139], v[42:43], v[138:139]
    v_pk_mul_f32 v[170:171], v[42:43], v[170:171]
    v_pk_mul_f32 v[202:203], v[42:43], v[202:203]
    v_pk_mul_f32 v[154:155], v[42:43], v[154:155]
    v_pk_mul_f32 v[186:187], v[42:43], v[186:187]
    v_pk_mul_f32 v[218:219], v[42:43], v[218:219]
    v_pk_fma_f32 v[88:89], v[48:49], v[84:85], v[138:139] op_sel:[0,0,0] op_sel_hi:[0,1,1]
    v_pk_fma_f32 v[96:97], v[56:57], v[92:93], v[170:171] op_sel:[0,0,0] op_sel_hi:[0,1,1]
    v_pk_fma_f32 v[104:105], v[64:65], v[100:101], v[202:203] op_sel:[0,0,0] op_sel_hi:[0,1,1]
    v_pk_fma_f32 v[90:91], v[48:49], v[86:87], v[154:155] op_sel:[0,0,0] op_sel_hi:[0,1,1]
    v_pk_fma_f32 v[98:99], v[56:57], v[94:95], v[186:187] op_sel:[0,0,0] op_sel_hi:[0,1,1]
    v_pk_fma_f32 v[106:107], v[64:65], v[102:103], v[218:219] op_sel:[0,0,0] op_sel_hi:[0,1,1]
    v_pk_fma_f32 v[88:89], v[48:49], v[86:87], v[88:89] op_sel:[1,0,0] op_sel_hi:[1,1,1] neg_lo:[1,0,0] neg_hi:[1,0,0]
    v_pk_fma_f32 v[96:97], v[56:57], v[94:95], v[96:97] op_sel:[1,0,0] op_sel_hi:[1,1,1] neg_lo:[1,0,0] neg_hi:[1,0,0]
    v_pk_fma_f32 v[104:105], v[64:65], v[102:103], v[104:105] op_sel:[1,0,0] op_sel_hi:[1,1,1] neg_lo:[1,0,0] neg_hi:[1,0,0]
    v_pk_fma_f32 v[90:91], v[48:49], v[84:85], v[90:91] op_sel:[1,0,0] op_sel_hi:[1,1,1]
    v_pk_fma_f32 v[98:99], v[56:57], v[92:93], v[98:99] op_sel:[1,0,0] op_sel_hi:[1,1,1]
    v_pk_fma_f32 v[106:107], v[64:65], v[100:101], v[106:107] op_sel:[1,0,0] op_sel_hi:[1,1,1]
    s_waitcnt lgkmcnt(0)
    v_pk_fma_f32 v[140:141], v[54:55], v[28:29], v[140:141] op_sel:[0,0,0] op_sel_hi:[0,1,1] neg_lo:[1,0,0] neg_hi:[1,0,0]
    v_pk_fma_f32 v[172:173], v[62:63], v[28:29], v[172:173] op_sel:[0,0,0] op_sel_hi:[0,1,1] neg_lo:[1,0,0] neg_hi:[1,0,0]
    v_pk_fma_f32 v[204:205], v[70:71], v[28:29], v[204:205] op_sel:[0,0,0] op_sel_hi:[0,1,1] neg_lo:[1,0,0] neg_hi:[1,0,0]
    v_pk_fma_f32 v[156:157], v[54:55], v[28:29], v[156:157] op_sel:[1,0,0] op_sel_hi:[1,1,1] neg_lo:[1,0,0] neg_hi:[1,0,0]
    v_pk_fma_f32 v[188:189], v[62:63], v[28:29], v[188:189] op_sel:[1,0,0] op_sel_hi:[1,1,1] neg_lo:[1,0,0] neg_hi:[1,0,0]
    v_pk_fma_f32 v[220:221], v[70:71], v[28:29], v[220:221] op_sel:[1,0,0] op_sel_hi:[1,1,1] neg_lo:[1,0,0] neg_hi:[1,0,0]
    v_pk_mul_f32 v[140:141], v[44:45], v[140:141]
    v_pk_mul_f32 v[172:173], v[44:45], v[172:173]
    v_pk_mul_f32 v[204:205], v[44:45], v[204:205]
    v_pk_mul_f32 v[156:157], v[44:45], v[156:157]
    v_pk_mul_f32 v[188:189], v[44:45], v[188:189]
    v_pk_mul_f32 v[220:221], v[44:45], v[220:221]
    v_pk_fma_f32 v[84:85], v[48:49], v[88:89], v[140:141] op_sel:[0,0,0] op_sel_hi:[0,1,1]
    v_pk_fma_f32 v[92:93], v[56:57], v[96:97], v[172:173] op_sel:[0,0,0] op_sel_hi:[0,1,1]
    v_pk_fma_f32 v[100:101], v[64:65], v[104:105], v[204:205] op_sel:[0,0,0] op_sel_hi:[0,1,1]
    v_pk_fma_f32 v[86:87], v[48:49], v[90:91], v[156:157] op_sel:[0,0,0] op_sel_hi:[0,1,1]
    v_pk_fma_f32 v[94:95], v[56:57], v[98:99], v[188:189] op_sel:[0,0,0] op_sel_hi:[0,1,1]
    v_pk_fma_f32 v[102:103], v[64:65], v[106:107], v[220:221] op_sel:[0,0,0] op_sel_hi:[0,1,1]
    v_pk_fma_f32 v[84:85], v[48:49], v[90:91], v[84:85] op_sel:[1,0,0] op_sel_hi:[1,1,1] neg_lo:[1,0,0] neg_hi:[1,0,0]
    v_pk_fma_f32 v[92:93], v[56:57], v[98:99], v[92:93] op_sel:[1,0,0] op_sel_hi:[1,1,1] neg_lo:[1,0,0] neg_hi:[1,0,0]
    v_pk_fma_f32 v[100:101], v[64:65], v[106:107], v[100:101] op_sel:[1,0,0] op_sel_hi:[1,1,1] neg_lo:[1,0,0] neg_hi:[1,0,0]
    v_pk_fma_f32 v[86:87], v[48:49], v[88:89], v[86:87] op_sel:[1,0,0] op_sel_hi:[1,1,1]
    v_pk_fma_f32 v[94:95], v[56:57], v[96:97], v[94:95] op_sel:[1,0,0] op_sel_hi:[1,1,1]
    v_pk_fma_f32 v[102:103], v[64:65], v[104:105], v[102:103] op_sel:[1,0,0] op_sel_hi:[1,1,1]
    v_pk_fma_f32 v[142:143], v[54:55], v[30:31], v[142:143] op_sel:[0,0,0] op_sel_hi:[0,1,1] neg_lo:[1,0,0] neg_hi:[1,0,0]
    v_pk_fma_f32 v[174:175], v[62:63], v[30:31], v[174:175] op_sel:[0,0,0] op_sel_hi:[0,1,1] neg_lo:[1,0,0] neg_hi:[1,0,0]
    v_pk_fma_f32 v[206:207], v[70:71], v[30:31], v[206:207] op_sel:[0,0,0] op_sel_hi:[0,1,1] neg_lo:[1,0,0] neg_hi:[1,0,0]
    v_pk_fma_f32 v[158:159], v[54:55], v[30:31], v[158:159] op_sel:[1,0,0] op_sel_hi:[1,1,1] neg_lo:[1,0,0] neg_hi:[1,0,0]
    v_pk_fma_f32 v[190:191], v[62:63], v[30:31], v[190:191] op_sel:[1,0,0] op_sel_hi:[1,1,1] neg_lo:[1,0,0] neg_hi:[1,0,0]
    v_pk_fma_f32 v[222:223], v[70:71], v[30:31], v[222:223] op_sel:[1,0,0] op_sel_hi:[1,1,1] neg_lo:[1,0,0] neg_hi:[1,0,0]
    v_pk_mul_f32 v[142:143], v[46:47], v[142:143]
    v_pk_mul_f32 v[174:175], v[46:47], v[174:175]
    v_pk_mul_f32 v[206:207], v[46:47], v[206:207]
    v_pk_mul_f32 v[158:159], v[46:47], v[158:159]
    v_pk_mul_f32 v[190:191], v[46:47], v[190:191]
    v_pk_mul_f32 v[222:223], v[46:47], v[222:223]
    v_pk_fma_f32 v[88:89], v[48:49], v[84:85], v[142:143] op_sel:[0,0,0] op_sel_hi:[0,1,1]
    v_pk_fma_f32 v[96:97], v[56:57], v[92:93], v[174:175] op_sel:[0,0,0] op_sel_hi:[0,1,1]
    v_pk_fma_f32 v[104:105], v[64:65], v[100:101], v[206:207] op_sel:[0,0,0] op_sel_hi:[0,1,1]
    v_pk_fma_f32 v[90:91], v[48:49], v[86:87], v[158:159] op_sel:[0,0,0] op_sel_hi:[0,1,1]
    v_pk_fma_f32 v[98:99], v[56:57], v[94:95], v[190:191] op_sel:[0,0,0] op_sel_hi:[0,1,1]
    v_pk_fma_f32 v[106:107], v[64:65], v[102:103], v[222:223] op_sel:[0,0,0] op_sel_hi:[0,1,1]
    v_pk_fma_f32 v[88:89], v[48:49], v[86:87], v[88:89] op_sel:[1,0,0] op_sel_hi:[1,1,1] neg_lo:[1,0,0] neg_hi:[1,0,0]
    v_pk_fma_f32 v[96:97], v[56:57], v[94:95], v[96:97] op_sel:[1,0,0] op_sel_hi:[1,1,1] neg_lo:[1,0,0] neg_hi:[1,0,0]
    v_pk_fma_f32 v[104:105], v[64:65], v[102:103], v[104:105] op_sel:[1,0,0] op_sel_hi:[1,1,1] neg_lo:[1,0,0] neg_hi:[1,0,0]
    v_pk_fma_f32 v[90:91], v[48:49], v[84:85], v[90:91] op_sel:[1,0,0] op_sel_hi:[1,1,1]
    v_pk_fma_f32 v[98:99], v[56:57], v[92:93], v[98:99] op_sel:[1,0,0] op_sel_hi:[1,1,1]
    v_pk_fma_f32 v[106:107], v[64:65], v[100:101], v[106:107] op_sel:[1,0,0] op_sel_hi:[1,1,1]
    v_fma_f32 v72, v52, v88, v89
    v_fma_f32 v73, v52, v90, v91
    v_fma_f32 v72, -v53, v90, v72
    v_fma_f32 v73, v53, v88, v73
    ds_write_b64 v10, v[72:73] offset:0
    v_fma_f32 v76, v60, v96, v97
    v_fma_f32 v77, v60, v98, v99
    v_fma_f32 v76, -v61, v98, v76
    v_fma_f32 v77, v61, v96, v77
    ds_write_b64 v10, v[76:77] offset:256
    v_fma_f32 v80, v68, v104, v105
    v_fma_f32 v81, v68, v106, v107
    v_fma_f32 v80, -v69, v106, v80
    v_fma_f32 v81, v69, v104, v81
    ds_write_b64 v10, v[80:81] offset:512
    s_waitcnt lgkmcnt(0)
    s_setprio 0
    s_barrier
    v_pk_mul_f32 v[72:73], v[50:51], v[128:129] op_sel:[1,0] op_sel_hi:[1,1]
    v_pk_mul_f32 v[128:129], v[50:51], v[128:129] op_sel:[0,0] op_sel_hi:[0,1]
    v_pk_fma_f32 v[128:129], v[50:51], v[144:145], v[128:129] op_sel:[1,0,0] op_sel_hi:[1,1,1] neg_lo:[1,0,0] neg_hi:[1,0,0]
    v_pk_fma_f32 v[144:145], v[50:51], v[144:145], v[72:73] op_sel:[0,0,0] op_sel_hi:[0,1,1]
    v_pk_mul_f32 v[76:77], v[58:59], v[160:161] op_sel:[1,0] op_sel_hi:[1,1]
    v_pk_mul_f32 v[160:161], v[58:59], v[160:161] op_sel:[0,0] op_sel_hi:[0,1]
    v_pk_fma_f32 v[160:161], v[58:59], v[176:177], v[160:161] op_sel:[1,0,0] op_sel_hi:[1,1,1] neg_lo:[1,0,0] neg_hi:[1,0,0]
    v_pk_fma_f32 v[176:177], v[58:59], v[176:177], v[76:77] op_sel:[0,0,0] op_sel_hi:[0,1,1]
    v_pk_mul_f32 v[80:81], v[66:67], v[192:193] op_sel:[1,0] op_sel_hi:[1,1]
    v_pk_mul_f32 v[192:193], v[66:67], v[192:193] op_sel:[0,0] op_sel_hi:[0,1]
    v_pk_fma_f32 v[192:193], v[66:67], v[208:209], v[192:193] op_sel:[1,0,0] op_sel_hi:[1,1,1] neg_lo:[1,0,0] neg_hi:[1,0,0]
    v_pk_fma_f32 v[208:209], v[66:67], v[208:209], v[80:81] op_sel:[0,0,0] op_sel_hi:[0,1,1]
    v_pk_mul_f32 v[72:73], v[50:51], v[130:131] op_sel:[1,0] op_sel_hi:[1,1]
    v_pk_mul_f32 v[130:131], v[50:51], v[130:131] op_sel:[0,0] op_sel_hi:[0,1]
    v_pk_fma_f32 v[130:131], v[50:51], v[146:147], v[130:131] op_sel:[1,0,0] op_sel_hi:[1,1,1] neg_lo:[1,0,0] neg_hi:[1,0,0]
    v_pk_fma_f32 v[146:147], v[50:51], v[146:147], v[72:73] op_sel:[0,0,0] op_sel_hi:[0,1,1]
    v_pk_mul_f32 v[76:77], v[58:59], v[162:163] op_sel:[1,0] op_sel_hi:[1,1]
    v_pk_mul_f32 v[162:163], v[58:59], v[162:163] op_sel:[0,0] op_sel_hi:[0,1]
    v_pk_fma_f32 v[162:163], v[58:59], v[178:179], v[162:163] op_sel:[1,0,0] op_sel_hi:[1,1,1] neg_lo:[1,0,0] neg_hi:[1,0,0]
    v_pk_fma_f32 v[178:179], v[58:59], v[178:179], v[76:77] op_sel:[0,0,0] op_sel_hi:[0,1,1]
    v_pk_mul_f32 v[80:81], v[66:67], v[194:195] op_sel:[1,0] op_sel_hi:[1,1]
    v_pk_mul_f32 v[194:195], v[66:67], v[194:195] op_sel:[0,0] op_sel_hi:[0,1]
    v_pk_fma_f32 v[194:195], v[66:67], v[210:211], v[194:195] op_sel:[1,0,0] op_sel_hi:[1,1,1] neg_lo:[1,0,0] neg_hi:[1,0,0]
    v_pk_fma_f32 v[210:211], v[66:67], v[210:211], v[80:81] op_sel:[0,0,0] op_sel_hi:[0,1,1]
    v_pk_mul_f32 v[72:73], v[50:51], v[132:133] op_sel:[1,0] op_sel_hi:[1,1]
    v_pk_mul_f32 v[132:133], v[50:51], v[132:133] op_sel:[0,0] op_sel_hi:[0,1]
    v_pk_fma_f32 v[132:133], v[50:51], v[148:149], v[132:133] op_sel:[1,0,0] op_sel_hi:[1,1,1] neg_lo:[1,0,0] neg_hi:[1,0,0]
    v_pk_fma_f32 v[148:149], v[50:51], v[148:149], v[72:73] op_sel:[0,0,0] op_sel_hi:[0,1,1]
    v_pk_mul_f32 v[76:77], v[58:59], v[164:165] op_sel:[1,0] op_sel_hi:[1,1]
    v_pk_mul_f32 v[164:165], v[58:59], v[164:165] op_sel:[0,0] op_sel_hi:[0,1]
    v_pk_fma_f32 v[164:165], v[58:59], v[180:181], v[164:165] op_sel:[1,0,0] op_sel_hi:[1,1,1] neg_lo:[1,0,0] neg_hi:[1,0,0]
    v_pk_fma_f32 v[180:181], v[58:59], v[180:181], v[76:77] op_sel:[0,0,0] op_sel_hi:[0,1,1]
    v_pk_mul_f32 v[80:81], v[66:67], v[196:197] op_sel:[1,0] op_sel_hi:[1,1]
    v_pk_mul_f32 v[196:197], v[66:67], v[196:197] op_sel:[0,0] op_sel_hi:[0,1]
    v_pk_fma_f32 v[196:197], v[66:67], v[212:213], v[196:197] op_sel:[1,0,0] op_sel_hi:[1,1,1] neg_lo:[1,0,0] neg_hi:[1,0,0]
    v_pk_fma_f32 v[212:213], v[66:67], v[212:213], v[80:81] op_sel:[0,0,0] op_sel_hi:[0,1,1]
    v_pk_mul_f32 v[72:73], v[50:51], v[134:135] op_sel:[1,0] op_sel_hi:[1,1]
    v_pk_mul_f32 v[134:135], v[50:51], v[134:135] op_sel:[0,0] op_sel_hi:[0,1]
    v_pk_fma_f32 v[134:135], v[50:51], v[150:151], v[134:135] op_sel:[1,0,0] op_sel_hi:[1,1,1] neg_lo:[1,0,0] neg_hi:[1,0,0]
    v_pk_fma_f32 v[150:151], v[50:51], v[150:151], v[72:73] op_sel:[0,0,0] op_sel_hi:[0,1,1]
    v_pk_mul_f32 v[76:77], v[58:59], v[166:167] op_sel:[1,0] op_sel_hi:[1,1]
    v_pk_mul_f32 v[166:167], v[58:59], v[166:167] op_sel:[0,0] op_sel_hi:[0,1]
    v_pk_fma_f32 v[166:167], v[58:59], v[182:183], v[166:167] op_sel:[1,0,0] op_sel_hi:[1,1,1] neg_lo:[1,0,0] neg_hi:[1,0,0]
    v_pk_fma_f32 v[182:183], v[58:59], v[182:183], v[76:77] op_sel:[0,0,0] op_sel_hi:[0,1,1]
    v_pk_mul_f32 v[80:81], v[66:67], v[198:199] op_sel:[1,0] op_sel_hi:[1,1]
    v_pk_mul_f32 v[198:199], v[66:67], v[198:199] op_sel:[0,0] op_sel_hi:[0,1]
    v_pk_fma_f32 v[198:199], v[66:67], v[214:215], v[198:199] op_sel:[1,0,0] op_sel_hi:[1,1,1] neg_lo:[1,0,0] neg_hi:[1,0,0]
    v_pk_fma_f32 v[214:215], v[66:67], v[214:215], v[80:81] op_sel:[0,0,0] op_sel_hi:[0,1,1]
    v_pk_mul_f32 v[72:73], v[50:51], v[136:137] op_sel:[1,0] op_sel_hi:[1,1]
    v_pk_mul_f32 v[136:137], v[50:51], v[136:137] op_sel:[0,0] op_sel_hi:[0,1]
    v_pk_fma_f32 v[136:137], v[50:51], v[152:153], v[136:137] op_sel:[1,0,0] op_sel_hi:[1,1,1] neg_lo:[1,0,0] neg_hi:[1,0,0]
    v_pk_fma_f32 v[152:153], v[50:51], v[152:153], v[72:73] op_sel:[0,0,0] op_sel_hi:[0,1,1]
    v_pk_mul_f32 v[76:77], v[58:59], v[168:169] op_sel:[1,0] op_sel_hi:[1,1]
    v_pk_mul_f32 v[168:169], v[58:59], v[168:169] op_sel:[0,0] op_sel_hi:[0,1]
    v_pk_fma_f32 v[168:169], v[58:59], v[184:185], v[168:169] op_sel:[1,0,0] op_sel_hi:[1,1,1] neg_lo:[1,0,0] neg_hi:[1,0,0]
    v_pk_fma_f32 v[184:185], v[58:59], v[184:185], v[76:77] op_sel:[0,0,0] op_sel_hi:[0,1,1]
    v_pk_mul_f32 v[80:81], v[66:67], v[200:201] op_sel:[1,0] op_sel_hi:[1,1]
    v_pk_mul_f32 v[200:201], v[66:67], v[200:201] op_sel:[0,0] op_sel_hi:[0,1]
    v_pk_fma_f32 v[200:201], v[66:67], v[216:217], v[200:201] op_sel:[1,0,0] op_sel_hi:[1,1,1] neg_lo:[1,0,0] neg_hi:[1,0,0]
    v_pk_fma_f32 v[216:217], v[66:67], v[216:217], v[80:81] op_sel:[0,0,0] op_sel_hi:[0,1,1]
    v_pk_mul_f32 v[72:73], v[50:51], v[138:139] op_sel:[1,0] op_sel_hi:[1,1]
    v_pk_mul_f32 v[138:139], v[50:51], v[138:139] op_sel:[0,0] op_sel_hi:[0,1]
    v_pk_fma_f32 v[138:139], v[50:51], v[154:155], v[138:139] op_sel:[1,0,0] op_sel_hi:[1,1,1] neg_lo:[1,0,0] neg_hi:[1,0,0]
    v_pk_fma_f32 v[154:155], v[50:51], v[154:155], v[72:73] op_sel:[0,0,0] op_sel_hi:[0,1,1]
    v_pk_mul_f32 v[76:77], v[58:59], v[170:171] op_sel:[1,0] op_sel_hi:[1,1]
    v_pk_mul_f32 v[170:171], v[58:59], v[170:171] op_sel:[0,0] op_sel_hi:[0,1]
    v_pk_fma_f32 v[170:171], v[58:59], v[186:187], v[170:171] op_sel:[1,0,0] op_sel_hi:[1,1,1] neg_lo:[1,0,0] neg_hi:[1,0,0]
    v_pk_fma_f32 v[186:187], v[58:59], v[186:187], v[76:77] op_sel:[0,0,0] op_sel_hi:[0,1,1]
    v_pk_mul_f32 v[80:81], v[66:67], v[202:203] op_sel:[1,0] op_sel_hi:[1,1]
    v_pk_mul_f32 v[202:203], v[66:67], v[202:203] op_sel:[0,0] op_sel_hi:[0,1]
    v_pk_fma_f32 v[202:203], v[66:67], v[218:219], v[202:203] op_sel:[1,0,0] op_sel_hi:[1,1,1] neg_lo:[1,0,0] neg_hi:[1,0,0]
    v_pk_fma_f32 v[218:219], v[66:67], v[218:219], v[80:81] op_sel:[0,0,0] op_sel_hi:[0,1,1]
    v_pk_mul_f32 v[72:73], v[50:51], v[140:141] op_sel:[1,0] op_sel_hi:[1,1]
    v_pk_mul_f32 v[140:141], v[50:51], v[140:141] op_sel:[0,0] op_sel_hi:[0,1]
    v_pk_fma_f32 v[140:141], v[50:51], v[156:157], v[140:141] op_sel:[1,0,0] op_sel_hi:[1,1,1] neg_lo:[1,0,0] neg_hi:[1,0,0]
    v_pk_fma_f32 v[156:157], v[50:51], v[156:157], v[72:73] op_sel:[0,0,0] op_sel_hi:[0,1,1]
    v_pk_mul_f32 v[76:77], v[58:59], v[172:173] op_sel:[1,0] op_sel_hi:[1,1]
    v_pk_mul_f32 v[172:173], v[58:59], v[172:173] op_sel:[0,0] op_sel_hi:[0,1]
    v_pk_fma_f32 v[172:173], v[58:59], v[188:189], v[172:173] op_sel:[1,0,0] op_sel_hi:[1,1,1] neg_lo:[1,0,0] neg_hi:[1,0,0]
    v_pk_fma_f32 v[188:189], v[58:59], v[188:189], v[76:77] op_sel:[0,0,0] op_sel_hi:[0,1,1]
    v_pk_mul_f32 v[80:81], v[66:67], v[204:205] op_sel:[1,0] op_sel_hi:[1,1]
    v_pk_mul_f32 v[204:205], v[66:67], v[204:205] op_sel:[0,0] op_sel_hi:[0,1]
    v_pk_fma_f32 v[204:205], v[66:67], v[220:221], v[204:205] op_sel:[1,0,0] op_sel_hi:[1,1,1] neg_lo:[1,0,0] neg_hi:[1,0,0]
    v_pk_fma_f32 v[220:221], v[66:67], v[220:221], v[80:81] op_sel:[0,0,0] op_sel_hi:[0,1,1]
    v_pk_mul_f32 v[72:73], v[50:51], v[142:143] op_sel:[1,0] op_sel_hi:[1,1]
    v_pk_mul_f32 v[142:143], v[50:51], v[142:143] op_sel:[0,0] op_sel_hi:[0,1]
    v_pk_fma_f32 v[142:143], v[50:51], v[158:159], v[142:143] op_sel:[1,0,0] op_sel_hi:[1,1,1] neg_lo:[1,0,0] neg_hi:[1,0,0]
    v_pk_fma_f32 v[158:159], v[50:51], v[158:159], v[72:73] op_sel:[0,0,0] op_sel_hi:[0,1,1]
    v_pk_mul_f32 v[76:77], v[58:59], v[174:175] op_sel:[1,0] op_sel_hi:[1,1]
    v_pk_mul_f32 v[174:175], v[58:59], v[174:175] op_sel:[0,0] op_sel_hi:[0,1]
    v_pk_fma_f32 v[174:175], v[58:59], v[190:191], v[174:175] op_sel:[1,0,0] op_sel_hi:[1,1,1] neg_lo:[1,0,0] neg_hi:[1,0,0]
    v_pk_fma_f32 v[190:191], v[58:59], v[190:191], v[76:77] op_sel:[0,0,0] op_sel_hi:[0,1,1]
    v_pk_mul_f32 v[80:81], v[66:67], v[206:207] op_sel:[1,0] op_sel_hi:[1,1]
    v_pk_mul_f32 v[206:207], v[66:67], v[206:207] op_sel:[0,0] op_sel_hi:[0,1]
    v_pk_fma_f32 v[206:207], v[66:67], v[222:223], v[206:207] op_sel:[1,0,0] op_sel_hi:[1,1,1] neg_lo:[1,0,0] neg_hi:[1,0,0]
    v_pk_fma_f32 v[222:223], v[66:67], v[222:223], v[80:81] op_sel:[0,0,0] op_sel_hi:[0,1,1]
    v_pk_mul_f32 v[72:73], v[50:51], v[88:89] op_sel:[1,0] op_sel_hi:[1,1]
    v_pk_mul_f32 v[88:89], v[50:51], v[88:89] op_sel:[0,0] op_sel_hi:[0,1]
    v_pk_fma_f32 v[88:89], v[50:51], v[90:91], v[88:89] op_sel:[1,0,0] op_sel_hi:[1,1,1] neg_lo:[1,0,0] neg_hi:[1,0,0]
    v_pk_fma_f32 v[90:91], v[50:51], v[90:91], v[72:73] op_sel:[0,0,0] op_sel_hi:[0,1,1]
    v_pk_mul_f32 v[76:77], v[58:59], v[96:97] op_sel:[1,0] op_sel_hi:[1,1]
    v_pk_mul_f32 v[96:97], v[58:59], v[96:97] op_sel:[0,0] op_sel_hi:[0,1]
    v_pk_fma_f32 v[96:97], v[58:59], v[98:99], v[96:97] op_sel:[1,0,0] op_sel_hi:[1,1,1] neg_lo:[1,0,0] neg_hi:[1,0,0]
    v_pk_fma_f32 v[98:99], v[58:59], v[98:99], v[76:77] op_sel:[0,0,0] op_sel_hi:[0,1,1]
    v_pk_mul_f32 v[80:81], v[66:67], v[104:105] op_sel:[1,0] op_sel_hi:[1,1]
    v_pk_mul_f32 v[104:105], v[66:67], v[104:105] op_sel:[0,0] op_sel_hi:[0,1]
    v_pk_fma_f32 v[104:105], v[66:67], v[106:107], v[104:105] op_sel:[1,0,0] op_sel_hi:[1,1,1] neg_lo:[1,0,0] neg_hi:[1,0,0]
    v_pk_fma_f32 v[106:107], v[66:67], v[106:107], v[80:81] op_sel:[0,0,0] op_sel_hi:[0,1,1]
    v_bfe_u32 v11, v3, 1, 2
    v_bfe_u32 v12, v3, 3, 1
    v_lshlrev_b32 v12, 1, v12
    v_xor_b32 v11, v11, v12
    v_lshlrev_b32 v12, 1, v4
    v_xor_b32 v11, v11, v12
    v_lshlrev_b32 v11, 4, v11
    v_lshl_add_u32 v11, v3, 6, v11
    s_lshl_b32 s78, s38, 13
    s_add_u32 s78, s78, 102400
    v_add_u32 v11, s78, v11
    v_xor_b32 v12, 16, v11
    v_lshrrev_b32 v13, 4, v2
    v_bfe_u32 v14, v2, 2, 2
    v_lshl_add_u32 v15, v13, 3, v14
    v_lshlrev_b32 v15, 6, v15
    v_lshrrev_b32 v14, 1, v14
    v_bfe_u32 v120, v2, 1, 1
    v_xor_b32 v14, v14, v120
    v_lshl_add_u32 v15, v14, 4, v15
    v_and_b32 v14, 1, v13
    v_lshl_add_u32 v15, v14, 5, v15
    v_and_b32 v14, 1, v2
    v_lshl_add_u32 v15, v14, 3, v15
    v_add_u32 v14, s78, v15
    v_xor_b32 v15, 32, v14
    v_bfe_u32 v120, v2, 1, 3
    v_and_b32 v121, 1, v2
    v_lshl_add_u32 v120, v121, 3, v120
    v_lshl_add_u32 v120, v13, 4, v120
    v_lshlrev_b32 v13, 4, v120
    s_lshl_b32 s77, s36, 1
    s_lshr_b32 s79, s38, 1
    s_add_u32 s77, s77, s79
    s_mul_i32 s77, s77, 393216
    s_mul_i32 s79, s40, 6
    s_add_u32 s79, s79, 54
    s_lshl_b32 s79, s79, 12
    s_add_u32 s77, s77, s79
    s_and_b32 s79, s38, 1
    s_lshl_b32 s79, s79, 11
    s_add_u32 s77, s77, s79
    s_setprio 3
    s_barrier
    ds_read_b64 v[72:73], v10 offset:6144
    ds_read_b64 v[76:77], v10 offset:6400
    ds_read_b64 v[80:81], v10 offset:6656
    s_waitcnt lgkmcnt(0)
    v_mov_b32 v84, v72
    v_mov_b32 v86, v73
    v_fma_f32 v85, v52, v72, v88
    v_fma_f32 v87, v52, v73, v90
    v_fma_f32 v85, -v53, v73, v85
    v_fma_f32 v87, v53, v72, v87
    v_pk_fma_f32 v[128:129], v[48:49], v[84:85], v[128:129] op_sel:[0,0,0] op_sel_hi:[0,1,1]
    v_pk_fma_f32 v[144:145], v[48:49], v[86:87], v[144:145] op_sel:[0,0,0] op_sel_hi:[0,1,1]
    v_pk_fma_f32 v[128:129], v[48:49], v[86:87], v[128:129] op_sel:[1,0,0] op_sel_hi:[1,1,1] neg_lo:[1,0,0] neg_hi:[1,0,0]
    v_pk_fma_f32 v[144:145], v[48:49], v[84:85], v[144:145] op_sel:[1,0,0] op_sel_hi:[1,1,1]
    v_cvt_pk_bf16_f32 v16, v128, v129
    v_cvt_pk_bf16_f32 v24, -v144, -v145
    v_pk_fma_f32 v[130:131], v[48:49], v[128:129], v[130:131] op_sel:[0,0,0] op_sel_hi:[0,1,1]
    v_pk_fma_f32 v[146:147], v[48:49], v[144:145], v[146:147] op_sel:[0,0,0] op_sel_hi:[0,1,1]
    v_pk_fma_f32 v[130:131], v[48:49], v[144:145], v[130:131] op_sel:[1,0,0] op_sel_hi:[1,1,1] neg_lo:[1,0,0] neg_hi:[1,0,0]
    v_pk_fma_f32 v[146:147], v[48:49], v[128:129], v[146:147] op_sel:[1,0,0] op_sel_hi:[1,1,1]
    v_cvt_pk_bf16_f32 v17, v130, v131
    v_cvt_pk_bf16_f32 v25, -v146, -v147
    v_pk_fma_f32 v[132:133], v[48:49], v[130:131], v[132:133] op_sel:[0,0,0] op_sel_hi:[0,1,1]
    v_pk_fma_f32 v[148:149], v[48:49], v[146:147], v[148:149] op_sel:[0,0,0] op_sel_hi:[0,1,1]
    v_pk_fma_f32 v[132:133], v[48:49], v[146:147], v[132:133] op_sel:[1,0,0] op_sel_hi:[1,1,1] neg_lo:[1,0,0] neg_hi:[1,0,0]
    v_pk_fma_f32 v[148:149], v[48:49], v[130:131], v[148:149] op_sel:[1,0,0] op_sel_hi:[1,1,1]
    v_cvt_pk_bf16_f32 v18, v132, v133
    v_cvt_pk_bf16_f32 v26, -v148, -v149
    v_pk_fma_f32 v[134:135], v[48:49], v[132:133], v[134:135] op_sel:[0,0,0] op_sel_hi:[0,1,1]
    v_pk_fma_f32 v[150:151], v[48:49], v[148:149], v[150:151] op_sel:[0,0,0] op_sel_hi:[0,1,1]
    v_pk_fma_f32 v[134:135], v[48:49], v[148:149], v[134:135] op_sel:[1,0,0] op_sel_hi:[1,1,1] neg_lo:[1,0,0] neg_hi:[1,0,0]
    v_pk_fma_f32 v[150:151], v[48:49], v[132:133], v[150:151] op_sel:[1,0,0] op_sel_hi:[1,1,1]
    v_cvt_pk_bf16_f32 v19, v134, v135
    v_cvt_pk_bf16_f32 v27, -v150, -v151
    ds_write_b128 v11, v[16:19] offset:0
    ds_write_b128 v11, v[24:27] offset:2048
    v_pk_fma_f32 v[136:137], v[48:49], v[134:135], v[136:137] op_sel:[0,0,0] op_sel_hi:[0,1,1]
    v_pk_fma_f32 v[152:153], v[48:49], v[150:151], v[152:153] op_sel:[0,0,0] op_sel_hi:[0,1,1]
    v_pk_fma_f32 v[136:137], v[48:49], v[150:151], v[136:137] op_sel:[1,0,0] op_sel_hi:[1,1,1] neg_lo:[1,0,0] neg_hi:[1,0,0]
    v_pk_fma_f32 v[152:153], v[48:49], v[134:135], v[152:153] op_sel:[1,0,0] op_sel_hi:[1,1,1]
    v_cvt_pk_bf16_f32 v20, v136, v137
    v_cvt_pk_bf16_f32 v28, -v152, -v153
    v_pk_fma_f32 v[138:139], v[48:49], v[136:137], v[138:139] op_sel:[0,0,0] op_sel_hi:[0,1,1]
    v_pk_fma_f32 v[154:155], v[48:49], v[152:153], v[154:155] op_sel:[0,0,0] op_sel_hi:[0,1,1]
    v_pk_fma_f32 v[138:139], v[48:49], v[152:153], v[138:139] op_sel:[1,0,0] op_sel_hi:[1,1,1] neg_lo:[1,0,0] neg_hi:[1,0,0]
    v_pk_fma_f32 v[154:155], v[48:49], v[136:137], v[154:155] op_sel:[1,0,0] op_sel_hi:[1,1,1]
    v_cvt_pk_bf16_f32 v21, v138, v139
    v_cvt_pk_bf16_f32 v29, -v154, -v155
    v_pk_fma_f32 v[140:141], v[48:49], v[138:139], v[140:141] op_sel:[0,0,0] op_sel_hi:[0,1,1]
    v_pk_fma_f32 v[156:157], v[48:49], v[154:155], v[156:157] op_sel:[0,0,0] op_sel_hi:[0,1,1]
    v_pk_fma_f32 v[140:141], v[48:49], v[154:155], v[140:141] op_sel:[1,0,0] op_sel_hi:[1,1,1] neg_lo:[1,0,0] neg_hi:[1,0,0]
    v_pk_fma_f32 v[156:157], v[48:49], v[138:139], v[156:157] op_sel:[1,0,0] op_sel_hi:[1,1,1]
    v_cvt_pk_bf16_f32 v22, v140, v141
    v_cvt_pk_bf16_f32 v30, -v156, -v157
    v_pk_fma_f32 v[142:143], v[48:49], v[140:141], v[142:143] op_sel:[0,0,0] op_sel_hi:[0,1,1]
    v_pk_fma_f32 v[158:159], v[48:49], v[156:157], v[158:159] op_sel:[0,0,0] op_sel_hi:[0,1,1]
    v_pk_fma_f32 v[142:143], v[48:49], v[156:157], v[142:143] op_sel:[1,0,0] op_sel_hi:[1,1,1] neg_lo:[1,0,0] neg_hi:[1,0,0]
    v_pk_fma_f32 v[158:159], v[48:49], v[140:141], v[158:159] op_sel:[1,0,0] op_sel_hi:[1,1,1]
    v_cvt_pk_bf16_f32 v23, v142, v143
    v_cvt_pk_bf16_f32 v31, -v158, -v159
    ds_write_b128 v12, v[20:23] offset:0
    ds_write_b128 v12, v[28:31] offset:2048
    v_mov_b32 v92, v76
    v_mov_b32 v94, v77
    v_fma_f32 v93, v60, v76, v96
    v_fma_f32 v95, v60, v77, v98
    v_fma_f32 v93, -v61, v77, v93
    v_fma_f32 v95, v61, v76, v95
    v_pk_fma_f32 v[160:161], v[56:57], v[92:93], v[160:161] op_sel:[0,0,0] op_sel_hi:[0,1,1]
    v_pk_fma_f32 v[176:177], v[56:57], v[94:95], v[176:177] op_sel:[0,0,0] op_sel_hi:[0,1,1]
    v_pk_fma_f32 v[160:161], v[56:57], v[94:95], v[160:161] op_sel:[1,0,0] op_sel_hi:[1,1,1] neg_lo:[1,0,0] neg_hi:[1,0,0]
    v_pk_fma_f32 v[176:177], v[56:57], v[92:93], v[176:177] op_sel:[1,0,0] op_sel_hi:[1,1,1]
    v_cvt_pk_bf16_f32 v32, v160, v161
    v_cvt_pk_bf16_f32 v40, -v176, -v177
    v_pk_fma_f32 v[162:163], v[56:57], v[160:161], v[162:163] op_sel:[0,0,0] op_sel_hi:[0,1,1]
    v_pk_fma_f32 v[178:179], v[56:57], v[176:177], v[178:179] op_sel:[0,0,0] op_sel_hi:[0,1,1]
    v_pk_fma_f32 v[162:163], v[56:57], v[176:177], v[162:163] op_sel:[1,0,0] op_sel_hi:[1,1,1] neg_lo:[1,0,0] neg_hi:[1,0,0]
    v_pk_fma_f32 v[178:179], v[56:57], v[160:161], v[178:179] op_sel:[1,0,0] op_sel_hi:[1,1,1]
    v_cvt_pk_bf16_f32 v33, v162, v163
    v_cvt_pk_bf16_f32 v41, -v178, -v179
    s_waitcnt lgkmcnt(0)
    ds_read_b64_tr_b16 v[224:225], v14 offset:0
    ds_read_b64_tr_b16 v[226:227], v15 offset:256
    ds_read_b64_tr_b16 v[228:229], v15 offset:0
    ds_read_b64_tr_b16 v[230:231], v14 offset:256
    ds_read_b64_tr_b16 v[232:233], v14 offset:2048
    ds_read_b64_tr_b16 v[234:235], v15 offset:2304
    ds_read_b64_tr_b16 v[236:237], v15 offset:2048
    ds_read_b64_tr_b16 v[238:239], v14 offset:2304
    v_pk_fma_f32 v[164:165], v[56:57], v[162:163], v[164:165] op_sel:[0,0,0] op_sel_hi:[0,1,1]
    v_pk_fma_f32 v[180:181], v[56:57], v[178:179], v[180:181] op_sel:[0,0,0] op_sel_hi:[0,1,1]
    v_pk_fma_f32 v[164:165], v[56:57], v[178:179], v[164:165] op_sel:[1,0,0] op_sel_hi:[1,1,1] neg_lo:[1,0,0] neg_hi:[1,0,0]
    v_pk_fma_f32 v[180:181], v[56:57], v[162:163], v[180:181] op_sel:[1,0,0] op_sel_hi:[1,1,1]
    v_cvt_pk_bf16_f32 v34, v164, v165
    v_cvt_pk_bf16_f32 v42, -v180, -v181
    v_pk_fma_f32 v[166:167], v[56:57], v[164:165], v[166:167] op_sel:[0,0,0] op_sel_hi:[0,1,1]
    v_pk_fma_f32 v[182:183], v[56:57], v[180:181], v[182:183] op_sel:[0,0,0] op_sel_hi:[0,1,1]
    v_pk_fma_f32 v[166:167], v[56:57], v[180:181], v[166:167] op_sel:[1,0,0] op_sel_hi:[1,1,1] neg_lo:[1,0,0] neg_hi:[1,0,0]
    v_pk_fma_f32 v[182:183], v[56:57], v[164:165], v[182:183] op_sel:[1,0,0] op_sel_hi:[1,1,1]
    v_cvt_pk_bf16_f32 v35, v166, v167
    v_cvt_pk_bf16_f32 v43, -v182, -v183
    ds_write_b128 v11, v[32:35] offset:4096
    ds_write_b128 v11, v[40:43] offset:6144
    v_pk_fma_f32 v[168:169], v[56:57], v[166:167], v[168:169] op_sel:[0,0,0] op_sel_hi:[0,1,1]
    v_pk_fma_f32 v[184:185], v[56:57], v[182:183], v[184:185] op_sel:[0,0,0] op_sel_hi:[0,1,1]
    v_pk_fma_f32 v[168:169], v[56:57], v[182:183], v[168:169] op_sel:[1,0,0] op_sel_hi:[1,1,1] neg_lo:[1,0,0] neg_hi:[1,0,0]
    v_pk_fma_f32 v[184:185], v[56:57], v[166:167], v[184:185] op_sel:[1,0,0] op_sel_hi:[1,1,1]
    v_cvt_pk_bf16_f32 v36, v168, v169
    v_cvt_pk_bf16_f32 v44, -v184, -v185
    v_pk_fma_f32 v[170:171], v[56:57], v[168:169], v[170:171] op_sel:[0,0,0] op_sel_hi:[0,1,1]
    v_pk_fma_f32 v[186:187], v[56:57], v[184:185], v[186:187] op_sel:[0,0,0] op_sel_hi:[0,1,1]
    v_pk_fma_f32 v[170:171], v[56:57], v[184:185], v[170:171] op_sel:[1,0,0] op_sel_hi:[1,1,1] neg_lo:[1,0,0] neg_hi:[1,0,0]
    v_pk_fma_f32 v[186:187], v[56:57], v[168:169], v[186:187] op_sel:[1,0,0] op_sel_hi:[1,1,1]
    v_cvt_pk_bf16_f32 v37, v170, v171
    v_cvt_pk_bf16_f32 v45, -v186, -v187
    s_waitcnt lgkmcnt(2)
    s_add_u32 s78, s77, 4096
    buffer_store_dwordx4 v[224:227], v13, s[56:59], s77 offen offset:0 sc1
    buffer_store_dwordx4 v[228:231], v13, s[56:59], s77 offen offset:1024 sc1
    buffer_store_dwordx4 v[232:235], v13, s[56:59], s78 offen offset:0 sc1
    buffer_store_dwordx4 v[236:239], v13, s[56:59], s78 offen offset:1024 sc1
    s_add_u32 s77, s77, 8192
    v_pk_fma_f32 v[172:173], v[56:57], v[170:171], v[172:173] op_sel:[0,0,0] op_sel_hi:[0,1,1]
    v_pk_fma_f32 v[188:189], v[56:57], v[186:187], v[188:189] op_sel:[0,0,0] op_sel_hi:[0,1,1]
    v_pk_fma_f32 v[172:173], v[56:57], v[186:187], v[172:173] op_sel:[1,0,0] op_sel_hi:[1,1,1] neg_lo:[1,0,0] neg_hi:[1,0,0]
    v_pk_fma_f32 v[188:189], v[56:57], v[170:171], v[188:189] op_sel:[1,0,0] op_sel_hi:[1,1,1]
    v_cvt_pk_bf16_f32 v38, v172, v173
    v_cvt_pk_bf16_f32 v46, -v188, -v189
    v_pk_fma_f32 v[174:175], v[56:57], v[172:173], v[174:175] op_sel:[0,0,0] op_sel_hi:[0,1,1]
    v_pk_fma_f32 v[190:191], v[56:57], v[188:189], v[190:191] op_sel:[0,0,0] op_sel_hi:[0,1,1]
    v_pk_fma_f32 v[174:175], v[56:57], v[188:189], v[174:175] op_sel:[1,0,0] op_sel_hi:[1,1,1] neg_lo:[1,0,0] neg_hi:[1,0,0]
    v_pk_fma_f32 v[190:191], v[56:57], v[172:173], v[190:191] op_sel:[1,0,0] op_sel_hi:[1,1,1]
    v_cvt_pk_bf16_f32 v39, v174, v175
    v_cvt_pk_bf16_f32 v47, -v190, -v191
    ds_write_b128 v12, v[36:39] offset:4096
    ds_write_b128 v12, v[44:47] offset:6144
    v_mov_b32 v100, v80
    v_mov_b32 v102, v81
    v_fma_f32 v101, v68, v80, v104
    v_fma_f32 v103, v68, v81, v106
    v_fma_f32 v101, -v69, v81, v101
    v_fma_f32 v103, v69, v80, v103
    v_pk_fma_f32 v[192:193], v[64:65], v[100:101], v[192:193] op_sel:[0,0,0] op_sel_hi:[0,1,1]
    v_pk_fma_f32 v[208:209], v[64:65], v[102:103], v[208:209] op_sel:[0,0,0] op_sel_hi:[0,1,1]
    v_pk_fma_f32 v[192:193], v[64:65], v[102:103], v[192:193] op_sel:[1,0,0] op_sel_hi:[1,1,1] neg_lo:[1,0,0] neg_hi:[1,0,0]
    v_pk_fma_f32 v[208:209], v[64:65], v[100:101], v[208:209] op_sel:[1,0,0] op_sel_hi:[1,1,1]
    v_cvt_pk_bf16_f32 v16, v192, v193
    v_cvt_pk_bf16_f32 v24, -v208, -v209
    v_pk_fma_f32 v[194:195], v[64:65], v[192:193], v[194:195] op_sel:[0,0,0] op_sel_hi:[0,1,1]
    v_pk_fma_f32 v[210:211], v[64:65], v[208:209], v[210:211] op_sel:[0,0,0] op_sel_hi:[0,1,1]
    v_pk_fma_f32 v[194:195], v[64:65], v[208:209], v[194:195] op_sel:[1,0,0] op_sel_hi:[1,1,1] neg_lo:[1,0,0] neg_hi:[1,0,0]
    v_pk_fma_f32 v[210:211], v[64:65], v[192:193], v[210:211] op_sel:[1,0,0] op_sel_hi:[1,1,1]
    v_cvt_pk_bf16_f32 v17, v194, v195
    v_cvt_pk_bf16_f32 v25, -v210, -v211
    s_waitcnt lgkmcnt(0)
    ds_read_b64_tr_b16 v[240:241], v14 offset:4096
    ds_read_b64_tr_b16 v[242:243], v15 offset:4352
    ds_read_b64_tr_b16 v[244:245], v15 offset:4096
    ds_read_b64_tr_b16 v[246:247], v14 offset:4352
    ds_read_b64_tr_b16 v[248:249], v14 offset:6144
    ds_read_b64_tr_b16 v[250:251], v15 offset:6400
    ds_read_b64_tr_b16 v[252:253], v15 offset:6144
    ds_read_b64_tr_b16 v[254:255], v14 offset:6400
    v_pk_fma_f32 v[196:197], v[64:65], v[194:195], v[196:197] op_sel:[0,0,0] op_sel_hi:[0,1,1]
    v_pk_fma_f32 v[212:213], v[64:65], v[210:211], v[212:213] op_sel:[0,0,0] op_sel_hi:[0,1,1]
    v_pk_fma_f32 v[196:197], v[64:65], v[210:211], v[196:197] op_sel:[1,0,0] op_sel_hi:[1,1,1] neg_lo:[1,0,0] neg_hi:[1,0,0]
    v_pk_fma_f32 v[212:213], v[64:65], v[194:195], v[212:213] op_sel:[1,0,0] op_sel_hi:[1,1,1]
    v_cvt_pk_bf16_f32 v18, v196, v197
    v_cvt_pk_bf16_f32 v26, -v212, -v213
    v_pk_fma_f32 v[198:199], v[64:65], v[196:197], v[198:199] op_sel:[0,0,0] op_sel_hi:[0,1,1]
    v_pk_fma_f32 v[214:215], v[64:65], v[212:213], v[214:215] op_sel:[0,0,0] op_sel_hi:[0,1,1]
    v_pk_fma_f32 v[198:199], v[64:65], v[212:213], v[198:199] op_sel:[1,0,0] op_sel_hi:[1,1,1] neg_lo:[1,0,0] neg_hi:[1,0,0]
    v_pk_fma_f32 v[214:215], v[64:65], v[196:197], v[214:215] op_sel:[1,0,0] op_sel_hi:[1,1,1]
    v_cvt_pk_bf16_f32 v19, v198, v199
    v_cvt_pk_bf16_f32 v27, -v214, -v215
    ds_write_b128 v11, v[16:19] offset:0
    ds_write_b128 v11, v[24:27] offset:2048
    v_pk_fma_f32 v[200:201], v[64:65], v[198:199], v[200:201] op_sel:[0,0,0] op_sel_hi:[0,1,1]
    v_pk_fma_f32 v[216:217], v[64:65], v[214:215], v[216:217] op_sel:[0,0,0] op_sel_hi:[0,1,1]
    v_pk_fma_f32 v[200:201], v[64:65], v[214:215], v[200:201] op_sel:[1,0,0] op_sel_hi:[1,1,1] neg_lo:[1,0,0] neg_hi:[1,0,0]
    v_pk_fma_f32 v[216:217], v[64:65], v[198:199], v[216:217] op_sel:[1,0,0] op_sel_hi:[1,1,1]
    v_cvt_pk_bf16_f32 v20, v200, v201
    v_cvt_pk_bf16_f32 v28, -v216, -v217
    v_pk_fma_f32 v[202:203], v[64:65], v[200:201], v[202:203] op_sel:[0,0,0] op_sel_hi:[0,1,1]
    v_pk_fma_f32 v[218:219], v[64:65], v[216:217], v[218:219] op_sel:[0,0,0] op_sel_hi:[0,1,1]
    v_pk_fma_f32 v[202:203], v[64:65], v[216:217], v[202:203] op_sel:[1,0,0] op_sel_hi:[1,1,1] neg_lo:[1,0,0] neg_hi:[1,0,0]
    v_pk_fma_f32 v[218:219], v[64:65], v[200:201], v[218:219] op_sel:[1,0,0] op_sel_hi:[1,1,1]
    v_cvt_pk_bf16_f32 v21, v202, v203
    v_cvt_pk_bf16_f32 v29, -v218, -v219
    s_waitcnt lgkmcnt(2)
    s_add_u32 s78, s77, 4096
    buffer_store_dwordx4 v[240:243], v13, s[56:59], s77 offen offset:0 sc1
    buffer_store_dwordx4 v[244:247], v13, s[56:59], s77 offen offset:1024 sc1
    buffer_store_dwordx4 v[248:251], v13, s[56:59], s78 offen offset:0 sc1
    buffer_store_dwordx4 v[252:255], v13, s[56:59], s78 offen offset:1024 sc1
    s_add_u32 s77, s77, 8192
    v_pk_fma_f32 v[204:205], v[64:65], v[202:203], v[204:205] op_sel:[0,0,0] op_sel_hi:[0,1,1]
    v_pk_fma_f32 v[220:221], v[64:65], v[218:219], v[220:221] op_sel:[0,0,0] op_sel_hi:[0,1,1]
    v_pk_fma_f32 v[204:205], v[64:65], v[218:219], v[204:205] op_sel:[1,0,0] op_sel_hi:[1,1,1] neg_lo:[1,0,0] neg_hi:[1,0,0]
    v_pk_fma_f32 v[220:221], v[64:65], v[202:203], v[220:221] op_sel:[1,0,0] op_sel_hi:[1,1,1]
    v_cvt_pk_bf16_f32 v22, v204, v205
    v_cvt_pk_bf16_f32 v30, -v220, -v221
    v_pk_fma_f32 v[206:207], v[64:65], v[204:205], v[206:207] op_sel:[0,0,0] op_sel_hi:[0,1,1]
    v_pk_fma_f32 v[222:223], v[64:65], v[220:221], v[222:223] op_sel:[0,0,0] op_sel_hi:[0,1,1]
    v_pk_fma_f32 v[206:207], v[64:65], v[220:221], v[206:207] op_sel:[1,0,0] op_sel_hi:[1,1,1] neg_lo:[1,0,0] neg_hi:[1,0,0]
    v_pk_fma_f32 v[222:223], v[64:65], v[204:205], v[222:223] op_sel:[1,0,0] op_sel_hi:[1,1,1]
    v_cvt_pk_bf16_f32 v23, v206, v207
    v_cvt_pk_bf16_f32 v31, -v222, -v223
    ds_write_b128 v12, v[20:23] offset:0
    ds_write_b128 v12, v[28:31] offset:2048
    s_waitcnt lgkmcnt(0)
    ds_read_b64_tr_b16 v[224:225], v14 offset:0
    ds_read_b64_tr_b16 v[226:227], v15 offset:256
    ds_read_b64_tr_b16 v[228:229], v15 offset:0
    ds_read_b64_tr_b16 v[230:231], v14 offset:256
    ds_read_b64_tr_b16 v[232:233], v14 offset:2048
    ds_read_b64_tr_b16 v[234:235], v15 offset:2304
    ds_read_b64_tr_b16 v[236:237], v15 offset:2048
    ds_read_b64_tr_b16 v[238:239], v14 offset:2304
    s_waitcnt lgkmcnt(0)
    s_add_u32 s78, s77, 4096
    buffer_store_dwordx4 v[224:227], v13, s[56:59], s77 offen offset:0 sc1
    buffer_store_dwordx4 v[228:231], v13, s[56:59], s77 offen offset:1024 sc1
    buffer_store_dwordx4 v[232:235], v13, s[56:59], s78 offen offset:0 sc1
    buffer_store_dwordx4 v[236:239], v13, s[56:59], s78 offen offset:1024 sc1
    s_add_u32 s77, s77, 8192
K_cpub:
    v_mov_b32 v13, 160768
    ds_read_b32 v15, v13
    s_lshl_b32 s74, s36, 1
    s_lshr_b32 s75, s38, 1
    s_add_u32 s74, s74, s75
    s_lshl_b32 s74, s74, 11
    s_add_u32 s74, s74, 17563648
    s_lshl_b32 s75, s37, 7
    s_add_u32 s75, s75, s74
    s_and_b32 s76, s38, 1
    s_lshl_b32 s76, s76, 2
    s_add_u32 s75, s75, s76
    s_lshl_b32 s76, s96, 10
    s_add_u32 s74, s74, s76
    s_mov_b32 s80, 131072
    v_mov_b32 v10, 1
    v_mov_b32 v9, 0
    v_and_b32 v12, 7, v2
    v_lshlrev_b32 v12, 7, v12
    v_add_u32 v8, 40960, v7
    s_mov_b32 s72, 2
    s_mov_b32 s73, 12
    s_mov_b32 s94, 20480
    s_mov_b32 s16, 0
    s_mul_i32 s84, s38, 10240
    s_add_u32 s84, s84, 102400
    s_nop 0
    v_lshrrev_b32 v36, 4, v2
    v_xor_b32 v36, v36, v2
    v_lshl_add_u32 v40, v36, 4, s84
    v_xor_b32 v41, 64, v40
    v_xor_b32 v42, 0x80, v40
    v_xor_b32 v43, 0xc0, v40
    v_mov_b32 v216, 0
    v_mov_b32 v217, 0
    v_mov_b32 v218, 0
    v_mov_b32 v219, 0
    v_mov_b32 v220, 0
    v_mov_b32 v221, 0
    v_mov_b32 v222, 0
    v_mov_b32 v223, 0
    v_mov_b32 v224, 0
    v_mov_b32 v225, 0
    v_mov_b32 v226, 0
    v_mov_b32 v227, 0
    v_mov_b32 v228, 0
    v_mov_b32 v229, 0
    v_mov_b32 v230, 0
    v_mov_b32 v231, 0
    v_mov_b32 v232, 0
    v_mov_b32 v233, 0
    v_mov_b32 v234, 0
    v_mov_b32 v235, 0
    v_mov_b32 v236, 0
    v_mov_b32 v237, 0
    v_mov_b32 v238, 0
    v_mov_b32 v239, 0
    v_mov_b32 v240, 0
    v_mov_b32 v241, 0
    v_mov_b32 v242, 0
    v_mov_b32 v243, 0
    v_mov_b32 v244, 0
    v_mov_b32 v245, 0
    v_mov_b32 v246, 0
    v_mov_b32 v247, 0
    v_mov_b32 v248, 0
    v_mov_b32 v249, 0
    v_mov_b32 v250, 0
    v_mov_b32 v251, 0
    v_mov_b32 v252, 0
    v_mov_b32 v253, 0
    v_mov_b32 v254, 0
    v_mov_b32 v255, 0
    s_add_u32 s77, s75, 0x10000
    s_bitcmp1_b32 0xc0c0, s37
    s_cselect_b32 s77, s77, 0x7fff0000
    v_min_u32 v12, 0x280, v12
    s_cmp_eq_u32 s96, 0
    s_cselect_b32 s83, 5, 99
    s_cselect_b32 s82, 1, 99
    s_waitcnt lgkmcnt(0)
    v_readfirstlane_b32 s95, v15
    s_cmp_eq_u32 s96, 0
    s_cbranch_scc1 K_ph0_9
    v_mov_b32 v13, 160772
    s_mov_b32 s80, 6
K_sp_10:
    s_sub_u32 s80, s80, 1
    s_cmp_eq_u32 s80, 0
    s_cbranch_scc1 K_slow_7
    ds_read_b32 v14, v13
    s_waitcnt lgkmcnt(0)
    v_cmp_ne_u32 vcc, 1, v14
    s_cbranch_vccnz K_sp_10
    buffer_load_dwordx4 v[112:115], v7, s[4:7], s16 offen offset:0 sc1
    buffer_load_dwordx4 v[116:119], v7, s[4:7], s16 offen offset:1024 sc1
    s_add_u32 s16, s16, 4096
    buffer_load_dwordx4 v[120:123], v7, s[4:7], s16 offen offset:0 sc1
    buffer_load_dwordx4 v[124:127], v7, s[4:7], s16 offen offset:1024 sc1
    s_add_u32 s16, s16, 4096
    buffer_load_dwordx4 v[128:131], v7, s[4:7], s16 offen offset:0 sc1
    buffer_load_dwordx4 v[132:135], v7, s[4:7], s16 offen offset:1024 sc1
    s_add_u32 s16, s16, 4096
    buffer_load_dwordx4 v[136:139], v7, s[4:7], s16 offen offset:0 sc1
    buffer_load_dwordx4 v[140:143], v7, s[4:7], s16 offen offset:1024 sc1
    s_add_u32 s16, s16, 4096
    buffer_load_dwordx4 v[144:147], v7, s[4:7], s16 offen offset:0 sc1
    buffer_load_dwordx4 v[148:151], v7, s[4:7], s16 offen offset:1024 sc1
    s_add_u32 s16, s16, 4096
    buffer_load_dwordx4 v[152:155], v7, s[4:7], s16 offen offset:0 sc1
    buffer_load_dwordx4 v[156:159], v7, s[4:7], s16 offen offset:1024 sc1
    s_add_u32 s16, s16, 4096
    buffer_load_dwordx4 v[160:163], v7, s[4:7], s16 offen offset:0 sc1
    buffer_load_dwordx4 v[164:167], v7, s[4:7], s16 offen offset:1024 sc1
    s_add_u32 s16, s16, 4096
    buffer_load_dwordx4 v[168:171], v7, s[4:7], s16 offen offset:0 sc1
    s_waitcnt vmcnt(15)
    s_mov_b64 exec, 1
    s_cmp_ge_u32 s95, 1
    s_cbranch_scc1 K_gs_11
    buffer_store_dword v10, v9, s[56:59], s75 offen sc1
    s_branch K_ge_12
K_gs_11:
    buffer_store_dword v10, v9, s[56:59], s75 offen
K_ge_12:
    buffer_store_dword v10, v9, s[56:59], s77 offen sc1
    s_mov_b64 exec, -1
    s_barrier
    s_branch K_pj_8
K_slow_7:
    s_waitcnt vmcnt(0)
    s_mov_b64 exec, 1
    s_cmp_ge_u32 s95, 1
    s_cbranch_scc1 K_gs_13
    buffer_store_dword v10, v9, s[56:59], s75 offen sc1
    s_branch K_ge_14
K_gs_13:
    buffer_store_dword v10, v9, s[56:59], s75 offen
K_ge_14:
    buffer_store_dword v10, v9, s[56:59], s77 offen sc1
    s_mov_b64 exec, -1
    s_barrier
    buffer_load_dwordx4 v[112:115], v7, s[4:7], s16 offen offset:0 sc1
    buffer_load_dwordx4 v[116:119], v7, s[4:7], s16 offen offset:1024 sc1
    s_add_u32 s16, s16, 4096
    buffer_load_dwordx4 v[120:123], v7, s[4:7], s16 offen offset:0 sc1
    buffer_load_dwordx4 v[124:127], v7, s[4:7], s16 offen offset:1024 sc1
    s_add_u32 s16, s16, 4096
    buffer_load_dwordx4 v[128:131], v7, s[4:7], s16 offen offset:0 sc1
    buffer_load_dwordx4 v[132:135], v7, s[4:7], s16 offen offset:1024 sc1
    s_add_u32 s16, s16, 4096
    buffer_load_dwordx4 v[136:139], v7, s[4:7], s16 offen offset:0 sc1
    buffer_load_dwordx4 v[140:143], v7, s[4:7], s16 offen offset:1024 sc1
    s_add_u32 s16, s16, 4096
    buffer_load_dwordx4 v[144:147], v7, s[4:7], s16 offen offset:0 sc1
    buffer_load_dwordx4 v[148:151], v7, s[4:7], s16 offen offset:1024 sc1
    s_add_u32 s16, s16, 4096
    buffer_load_dwordx4 v[152:155], v7, s[4:7], s16 offen offset:0 sc1
    buffer_load_dwordx4 v[156:159], v7, s[4:7], s16 offen offset:1024 sc1
    s_add_u32 s16, s16, 4096
    buffer_load_dwordx4 v[160:163], v7, s[4:7], s16 offen offset:0 sc1
    buffer_load_dwordx4 v[164:167], v7, s[4:7], s16 offen offset:1024 sc1
    s_add_u32 s16, s16, 4096
    buffer_load_dwordx4 v[168:171], v7, s[4:7], s16 offen offset:0 sc1
    s_branch K_pj_8
K_ph0_9:
    s_waitcnt vmcnt(0)
    s_mov_b64 exec, 1
    s_cmp_ge_u32 s95, 1
    s_cbranch_scc1 K_gs_15
    buffer_store_dword v10, v9, s[56:59], s75 offen sc1
    s_branch K_ge_16
K_gs_15:
    buffer_store_dword v10, v9, s[56:59], s75 offen
K_ge_16:
    buffer_store_dword v10, v9, s[56:59], s77 offen sc1
    s_mov_b64 exec, -1
K_gp_17:
    buffer_load_dwordx2 v[14:15], v12, s[56:59], s74 offen sc1
    s_waitcnt vmcnt(0)
    v_and_b32 v14, v14, v15
    v_cmp_ne_u32 vcc, 1, v14
    s_cbranch_vccz K_gpok_18
    s_sleep 2
    s_sub_u32 s80, s80, 1
    s_cmp_lg_u32 s80, 0
    s_cbranch_scc1 K_gp_17
K_gpok_18:
    buffer_load_dwordx4 v[112:115], v7, s[4:7], s16 offen offset:0 sc1
    buffer_load_dwordx4 v[116:119], v7, s[4:7], s16 offen offset:1024 sc1
    s_add_u32 s16, s16, 4096
    buffer_load_dwordx4 v[120:123], v7, s[4:7], s16 offen offset:0 sc1
    buffer_load_dwordx4 v[124:127], v7, s[4:7], s16 offen offset:1024 sc1
    s_add_u32 s16, s16, 4096
    buffer_load_dwordx4 v[128:131], v7, s[4:7], s16 offen offset:0 sc1
    buffer_load_dwordx4 v[132:135], v7, s[4:7], s16 offen offset:1024 sc1
    s_add_u32 s16, s16, 4096
    buffer_load_dwordx4 v[136:139], v7, s[4:7], s16 offen offset:0 sc1
    buffer_load_dwordx4 v[140:143], v7, s[4:7], s16 offen offset:1024 sc1
    s_add_u32 s16, s16, 4096
    buffer_load_dwordx4 v[144:147], v7, s[4:7], s16 offen offset:0 sc1
    buffer_load_dwordx4 v[148:151], v7, s[4:7], s16 offen offset:1024 sc1
    s_add_u32 s16, s16, 4096
    buffer_load_dwordx4 v[152:155], v7, s[4:7], s16 offen offset:0 sc1
    buffer_load_dwordx4 v[156:159], v7, s[4:7], s16 offen offset:1024 sc1
    s_add_u32 s16, s16, 4096
    buffer_load_dwordx4 v[160:163], v7, s[4:7], s16 offen offset:0 sc1
    buffer_load_dwordx4 v[164:167], v7, s[4:7], s16 offen offset:1024 sc1
    s_add_u32 s16, s16, 4096
    buffer_load_dwordx4 v[168:171], v7, s[4:7], s16 offen offset:0 sc1
    s_barrier
K_pj_8:
    s_setprio 1
    ds_read_b128 v[176:179], v8 offset:0
    ds_read_b128 v[180:183], v8 offset:1024
    ds_read_b128 v[184:187], v8 offset:2048
    ds_read_b128 v[188:191], v8 offset:3072
    ds_read_b128 v[192:195], v8 offset:4096
K_c2loop:
    s_waitcnt vmcnt(13) lgkmcnt(0)
    v_mfma_f32_16x16x32_bf16 v[216:219], v[176:179], v[112:115], v[216:219]
    buffer_load_dwordx4 v[172:175], v7, s[4:7], s16 offen offset:1024 sc1
    s_add_u32 s16, s16, 4096
    v_mfma_f32_16x16x32_bf16 v[220:223], v[180:183], v[112:115], v[220:223]
    ds_read_b128 v[196:199], v8 offset:5120
    v_mfma_f32_16x16x32_bf16 v[224:227], v[184:187], v[112:115], v[224:227]
    ds_read_b128 v[200:203], v8 offset:6144
    v_mfma_f32_16x16x32_bf16 v[228:231], v[188:191], v[112:115], v[228:231]
    ds_read_b128 v[204:207], v8 offset:7168
    v_mfma_f32_16x16x32_bf16 v[232:235], v[192:195], v[112:115], v[232:235]
    ds_read_b128 v[208:211], v8 offset:8192
    v_mfma_f32_16x16x32_bf16 v[236:239], v[176:179], v[116:119], v[236:239]
    ds_read_b128 v[212:215], v8 offset:9216
    v_mfma_f32_16x16x32_bf16 v[240:243], v[180:183], v[116:119], v[240:243]
    buffer_load_dwordx4 v[112:115], v7, s[4:7], s16 offen offset:0 sc1
    v_mfma_f32_16x16x32_bf16 v[244:247], v[184:187], v[116:119], v[244:247]
    v_mfma_f32_16x16x32_bf16 v[248:251], v[188:191], v[116:119], v[248:251]
    v_mfma_f32_16x16x32_bf16 v[252:255], v[192:195], v[116:119], v[252:255]
    s_waitcnt vmcnt(13) lgkmcnt(0)
    v_mfma_f32_16x16x32_bf16 v[216:219], v[196:199], v[120:123], v[216:219]
    buffer_load_dwordx4 v[116:119], v7, s[4:7], s16 offen offset:1024 sc1
    s_add_u32 s16, s16, 4096
    v_mfma_f32_16x16x32_bf16 v[220:223], v[200:203], v[120:123], v[220:223]
    ds_read_b128 v[176:179], v8 offset:10240
    v_mfma_f32_16x16x32_bf16 v[224:227], v[204:207], v[120:123], v[224:227]
    ds_read_b128 v[180:183], v8 offset:11264
    v_mfma_f32_16x16x32_bf16 v[228:231], v[208:211], v[120:123], v[228:231]
    ds_read_b128 v[184:187], v8 offset:12288
    v_mfma_f32_16x16x32_bf16 v[232:235], v[212:215], v[120:123], v[232:235]
    ds_read_b128 v[188:191], v8 offset:13312
    v_mfma_f32_16x16x32_bf16 v[236:239], v[196:199], v[124:127], v[236:239]
    ds_read_b128 v[192:195], v8 offset:14336
    v_mfma_f32_16x16x32_bf16 v[240:243], v[200:203], v[124:127], v[240:243]
    buffer_load_dwordx4 v[120:123], v7, s[4:7], s16 offen offset:0 sc1
    v_mfma_f32_16x16x32_bf16 v[244:247], v[204:207], v[124:127], v[244:247]
    v_mfma_f32_16x16x32_bf16 v[248:251], v[208:211], v[124:127], v[248:251]
    v_mfma_f32_16x16x32_bf16 v[252:255], v[212:215], v[124:127], v[252:255]
    s_waitcnt vmcnt(13) lgkmcnt(0)
    v_mfma_f32_16x16x32_bf16 v[216:219], v[176:179], v[128:131], v[216:219]
    buffer_load_dwordx4 v[124:127], v7, s[4:7], s16 offen offset:1024 sc1
    s_add_u32 s16, s16, 4096
    v_mfma_f32_16x16x32_bf16 v[220:223], v[180:183], v[128:131], v[220:223]
    ds_read_b128 v[196:199], v8 offset:15360
    v_mfma_f32_16x16x32_bf16 v[224:227], v[184:187], v[128:131], v[224:227]
    ds_read_b128 v[200:203], v8 offset:16384
    v_mfma_f32_16x16x32_bf16 v[228:231], v[188:191], v[128:131], v[228:231]
    ds_read_b128 v[204:207], v8 offset:17408
    v_mfma_f32_16x16x32_bf16 v[232:235], v[192:195], v[128:131], v[232:235]
    ds_read_b128 v[208:211], v8 offset:18432
    v_mfma_f32_16x16x32_bf16 v[236:239], v[176:179], v[132:135], v[236:239]
    ds_read_b128 v[212:215], v8 offset:19456
    v_mfma_f32_16x16x32_bf16 v[240:243], v[180:183], v[132:135], v[240:243]
    buffer_load_dwordx4 v[128:131], v7, s[4:7], s16 offen offset:0 sc1
    v_mfma_f32_16x16x32_bf16 v[244:247], v[184:187], v[132:135], v[244:247]
    s_add_u32 s72, s72, 1
    s_cmp_eq_u32 s72, 5
    v_mfma_f32_16x16x32_bf16 v[248:251], v[188:191], v[132:135], v[248:251]
    s_cselect_b32 s72, 0, s72
    s_cselect_b32 s74, 4294885376, s94
    v_mfma_f32_16x16x32_bf16 v[252:255], v[192:195], v[132:135], v[252:255]
    v_add_u32 v8, s74, v8
    s_waitcnt vmcnt(13) lgkmcnt(0)
    v_mfma_f32_16x16x32_bf16 v[216:219], v[196:199], v[136:139], v[216:219]
    s_cmp_lt_u32 s73, 5
    s_cbranch_scc1 K_nb_19
    s_barrier
K_nb_19:
    buffer_load_dwordx4 v[132:135], v7, s[4:7], s16 offen offset:1024 sc1
    s_add_u32 s16, s16, 4096
    v_mfma_f32_16x16x32_bf16 v[220:223], v[200:203], v[136:139], v[220:223]
    ds_read_b128 v[176:179], v8 offset:0
    v_mfma_f32_16x16x32_bf16 v[224:227], v[204:207], v[136:139], v[224:227]
    ds_read_b128 v[180:183], v8 offset:1024
    v_mfma_f32_16x16x32_bf16 v[228:231], v[208:211], v[136:139], v[228:231]
    ds_read_b128 v[184:187], v8 offset:2048
    v_mfma_f32_16x16x32_bf16 v[232:235], v[212:215], v[136:139], v[232:235]
    ds_read_b128 v[188:191], v8 offset:3072
    v_mfma_f32_16x16x32_bf16 v[236:239], v[196:199], v[140:143], v[236:239]
    ds_read_b128 v[192:195], v8 offset:4096
    v_mfma_f32_16x16x32_bf16 v[240:243], v[200:203], v[140:143], v[240:243]
    buffer_load_dwordx4 v[136:139], v7, s[4:7], s16 offen offset:0 sc1
    v_mfma_f32_16x16x32_bf16 v[244:247], v[204:207], v[140:143], v[244:247]
    v_mfma_f32_16x16x32_bf16 v[248:251], v[208:211], v[140:143], v[248:251]
    s_sub_u32 s73, s73, 1
    s_cmp_eq_u32 s73, 0
    v_mfma_f32_16x16x32_bf16 v[252:255], v[212:215], v[140:143], v[252:255]
    s_waitcnt vmcnt(13) lgkmcnt(0)
    v_mfma_f32_16x16x32_bf16 v[216:219], v[176:179], v[144:147], v[216:219]
    buffer_load_dwordx4 v[140:143], v7, s[4:7], s16 offen offset:1024 sc1
    s_add_u32 s16, s16, 4096
    v_mfma_f32_16x16x32_bf16 v[220:223], v[180:183], v[144:147], v[220:223]
    s_cmp_eq_u32 s73, s83
    ds_read_b128 v[196:199], v8 offset:5120
    v_mfma_f32_16x16x32_bf16 v[224:227], v[184:187], v[144:147], v[224:227]
    s_cselect_b32 s74, 196608, 0
    ds_read_b128 v[200:203], v8 offset:6144
    v_mfma_f32_16x16x32_bf16 v[228:231], v[188:191], v[144:147], v[228:231]
    s_add_u32 s16, s16, s74
    ds_read_b128 v[204:207], v8 offset:7168
    v_mfma_f32_16x16x32_bf16 v[232:235], v[192:195], v[144:147], v[232:235]
    ds_read_b128 v[208:211], v8 offset:8192
    v_mfma_f32_16x16x32_bf16 v[236:239], v[176:179], v[148:151], v[236:239]
    ds_read_b128 v[212:215], v8 offset:9216
    v_mfma_f32_16x16x32_bf16 v[240:243], v[180:183], v[148:151], v[240:243]
    buffer_load_dwordx4 v[144:147], v7, s[4:7], s16 offen offset:0 sc1
    v_mfma_f32_16x16x32_bf16 v[244:247], v[184:187], v[148:151], v[244:247]
    v_mfma_f32_16x16x32_bf16 v[248:251], v[188:191], v[148:151], v[248:251]
    v_mfma_f32_16x16x32_bf16 v[252:255], v[192:195], v[148:151], v[252:255]
    s_waitcnt vmcnt(13) lgkmcnt(0)
    v_mfma_f32_16x16x32_bf16 v[216:219], v[196:199], v[152:155], v[216:219]
    buffer_load_dwordx4 v[148:151], v7, s[4:7], s16 offen offset:1024 sc1
    s_add_u32 s16, s16, 4096
    v_mfma_f32_16x16x32_bf16 v[220:223], v[200:203], v[152:155], v[220:223]
    ds_read_b128 v[176:179], v8 offset:10240
    v_mfma_f32_16x16x32_bf16 v[224:227], v[204:207], v[152:155], v[224:227]
    ds_read_b128 v[180:183], v8 offset:11264
    v_mfma_f32_16x16x32_bf16 v[228:231], v[208:211], v[152:155], v[228:231]
    ds_read_b128 v[184:187], v8 offset:12288
    v_mfma_f32_16x16x32_bf16 v[232:235], v[212:215], v[152:155], v[232:235]
    ds_read_b128 v[188:191], v8 offset:13312
    v_mfma_f32_16x16x32_bf16 v[236:239], v[196:199], v[156:159], v[236:239]
    ds_read_b128 v[192:195], v8 offset:14336
    v_mfma_f32_16x16x32_bf16 v[240:243], v[200:203], v[156:159], v[240:243]
    buffer_load_dwordx4 v[152:155], v7, s[4:7], s16 offen offset:0 sc1
    v_mfma_f32_16x16x32_bf16 v[244:247], v[204:207], v[156:159], v[244:247]
    v_mfma_f32_16x16x32_bf16 v[248:251], v[208:211], v[156:159], v[248:251]
    s_cmp_eq_u32 s73, s82
    v_mfma_f32_16x16x32_bf16 v[252:255], v[212:215], v[156:159], v[252:255]
    s_cbranch_scc1 K_c2end
    s_waitcnt vmcnt(13) lgkmcnt(0)
    v_mfma_f32_16x16x32_bf16 v[216:219], v[176:179], v[160:163], v[216:219]
    buffer_load_dwordx4 v[156:159], v7, s[4:7], s16 offen offset:1024 sc1
    s_add_u32 s16, s16, 4096
    v_mfma_f32_16x16x32_bf16 v[220:223], v[180:183], v[160:163], v[220:223]
    ds_read_b128 v[196:199], v8 offset:15360
    v_mfma_f32_16x16x32_bf16 v[224:227], v[184:187], v[160:163], v[224:227]
    ds_read_b128 v[200:203], v8 offset:16384
    v_mfma_f32_16x16x32_bf16 v[228:231], v[188:191], v[160:163], v[228:231]
    ds_read_b128 v[204:207], v8 offset:17408
    v_mfma_f32_16x16x32_bf16 v[232:235], v[192:195], v[160:163], v[232:235]
    ds_read_b128 v[208:211], v8 offset:18432
    v_mfma_f32_16x16x32_bf16 v[236:239], v[176:179], v[164:167], v[236:239]
    ds_read_b128 v[212:215], v8 offset:19456
    v_mfma_f32_16x16x32_bf16 v[240:243], v[180:183], v[164:167], v[240:243]
    buffer_load_dwordx4 v[160:163], v7, s[4:7], s16 offen offset:0 sc1
    v_mfma_f32_16x16x32_bf16 v[244:247], v[184:187], v[164:167], v[244:247]
    s_add_u32 s72, s72, 1
    s_cmp_eq_u32 s72, 5
    v_mfma_f32_16x16x32_bf16 v[248:251], v[188:191], v[164:167], v[248:251]
    s_cselect_b32 s72, 0, s72
    s_cselect_b32 s74, 4294885376, s94
    v_mfma_f32_16x16x32_bf16 v[252:255], v[192:195], v[164:167], v[252:255]
    v_add_u32 v8, s74, v8
    s_waitcnt vmcnt(13) lgkmcnt(0)
    v_mfma_f32_16x16x32_bf16 v[216:219], v[196:199], v[168:171], v[216:219]
    s_cmp_lt_u32 s73, 5
    s_cbranch_scc1 K_nb_20
    s_barrier
K_nb_20:
    buffer_load_dwordx4 v[164:167], v7, s[4:7], s16 offen offset:1024 sc1
    s_add_u32 s16, s16, 4096
    v_mfma_f32_16x16x32_bf16 v[220:223], v[200:203], v[168:171], v[220:223]
    ds_read_b128 v[176:179], v8 offset:0
    v_mfma_f32_16x16x32_bf16 v[224:227], v[204:207], v[168:171], v[224:227]
    ds_read_b128 v[180:183], v8 offset:1024
    v_mfma_f32_16x16x32_bf16 v[228:231], v[208:211], v[168:171], v[228:231]
    ds_read_b128 v[184:187], v8 offset:2048
    v_mfma_f32_16x16x32_bf16 v[232:235], v[212:215], v[168:171], v[232:235]
    ds_read_b128 v[188:191], v8 offset:3072
    v_mfma_f32_16x16x32_bf16 v[236:239], v[196:199], v[172:175], v[236:239]
    ds_read_b128 v[192:195], v8 offset:4096
    v_mfma_f32_16x16x32_bf16 v[240:243], v[200:203], v[172:175], v[240:243]
    buffer_load_dwordx4 v[168:171], v7, s[4:7], s16 offen offset:0 sc1
    v_mfma_f32_16x16x32_bf16 v[244:247], v[204:207], v[172:175], v[244:247]
    v_mfma_f32_16x16x32_bf16 v[248:251], v[208:211], v[172:175], v[248:251]
    s_sub_u32 s73, s73, 1
    s_cmp_eq_u32 s73, 0
    v_mfma_f32_16x16x32_bf16 v[252:255], v[212:215], v[172:175], v[252:255]
    s_cbranch_scc1 K_c2end
    s_branch K_c2loop
K_c2end:
    s_cmp_eq_u32 s96, 1
    s_cbranch_scc1 K_h1_21
    s_add_u32 s74, s18, 4096
    s_lshl_b32 s76, s38, 2
    s_add_u32 s76, s76, s19
    v_mov_b32 v10, 1
    v_mov_b32 v9, 0
    v_subrev_u32 v44, s84, v40
    v_subrev_u32 v45, s84, v41
    v_subrev_u32 v46, s84, v42
    v_subrev_u32 v47, s84, v43
    v_cvt_pk_bf16_f32 v48, v216, v217
    v_cvt_pk_bf16_f32 v49, v218, v219
    v_cvt_pk_bf16_f32 v50, v236, v237
    v_cvt_pk_bf16_f32 v51, v238, v239
    buffer_store_dwordx4 v[48:51], v44, s[56:59], s18 offen offset:0 sc1
    v_cvt_pk_bf16_f32 v52, v220, v221
    v_cvt_pk_bf16_f32 v53, v222, v223
    v_cvt_pk_bf16_f32 v54, v240, v241
    v_cvt_pk_bf16_f32 v55, v242, v243
    buffer_store_dwordx4 v[52:55], v45, s[56:59], s18 offen offset:1024 sc1
    v_cvt_pk_bf16_f32 v56, v224, v225
    v_cvt_pk_bf16_f32 v57, v226, v227
    v_cvt_pk_bf16_f32 v58, v244, v245
    v_cvt_pk_bf16_f32 v59, v246, v247
    buffer_store_dwordx4 v[56:59], v46, s[56:59], s18 offen offset:2048 sc1
    v_cvt_pk_bf16_f32 v60, v228, v229
    v_cvt_pk_bf16_f32 v61, v230, v231
    v_cvt_pk_bf16_f32 v62, v248, v249
    v_cvt_pk_bf16_f32 v63, v250, v251
    buffer_store_dwordx4 v[60:63], v47, s[56:59], s18 offen offset:3072 sc1
    v_cvt_pk_bf16_f32 v64, v232, v233
    v_cvt_pk_bf16_f32 v65, v234, v235
    v_cvt_pk_bf16_f32 v66, v252, v253
    v_cvt_pk_bf16_f32 v67, v254, v255
    buffer_store_dwordx4 v[64:67], v44, s[56:59], s74 offen offset:0 sc1
    s_waitcnt vmcnt(0)
    s_mov_b64 exec, 1
    buffer_store_dword v10, v9, s[56:59], s76 offen sc1
    s_mov_b64 exec, -1
    s_branch K_fin
K_h1_21:
    s_nop 3
    ds_write_b128 v40, v[216:219] offset:0
    ds_write_b128 v41, v[220:223] offset:1024
    ds_write_b128 v42, v[224:227] offset:2048
    ds_write_b128 v43, v[228:231] offset:3072
    ds_write_b128 v40, v[232:235] offset:4096
    s_waitcnt lgkmcnt(0)
    s_barrier
    ds_write_b128 v40, v[236:239] offset:5120
    ds_write_b128 v41, v[240:243] offset:6144
    ds_write_b128 v42, v[244:247] offset:7168
    ds_write_b128 v43, v[248:251] offset:8192
    ds_write_b128 v40, v[252:255] offset:9216
    s_waitcnt lgkmcnt(0)
    s_barrier
    s_branch K_fin
K_side:
    s_setprio 1
    s_and_b32 s81, s38, 1
    s_lshl_b32 s80, s81, 6
    v_add_u32 v14, s80, v2
    s_and_b32 s82, s97, 3
    s_and_b32 s85, s36, 3
    s_and_b32 s84, s75, 1
    s_cmp_eq_u32 s81, 1
    s_cselect_b32 s82, s85, s82
    s_cselect_b32 s84, s84, s76
    s_sub_u32 s84, 3, s84
    s_add_u32 s83, s41, s82
    s_sub_u32 s85, s83, 10
    s_cmp_lt_u32 s83, 10
    s_cselect_b32 s83, s83, s85
    s_cmp_lt_u32 s82, s84
    s_cselect_b32 s82, s82, 64
    s_mul_i32 s92, s36, 10240
    s_add_u32 s92, s92, 16777216
    s_mul_i32 s85, s37, 7680
    s_add_u32 s85, s85, 17039360
    s_cmp_eq_u32 s81, 1
    s_cselect_b32 s92, s85, s92
    s_movk_i32 s93, 1024
    s_cmov_b32 s93, 768
    s_mul_i32 s88, s83, s93
    s_add_u32 s88, s88, s92
    s_add_u32 s68, s34, s88
    s_addc_u32 s69, s35, 0
    s_mov_b32 s70, s93
    s_mov_b32 s71, 0x20000
    s_mov_b32 s64, s20
    s_mov_b32 s65, s21
    s_mov_b32 s66, 1280
    s_mov_b32 s67, 0x20000
    s_mul_i32 s80, s97, 160
    v_lshlrev_b32 v32, 2, v2
    buffer_load_dword v16, v32, s[64:67], s80 offen
    s_cmp_eq_u32 s39, 0
    s_cbranch_scc1 K_hffn_22
    s_mul_i32 s80, s40, 96
    v_add_u32 v32, s80, v14
    v_lshlrev_b32 v32, 1, v32
    s_mov_b32 s64, s6
    s_mov_b32 s65, s7
    s_mov_b32 s66, 1280
    s_mov_b32 s67, 0x20000
    buffer_load_ushort v17, v32, s[64:67], 0 offen
    s_mov_b32 s64, s8
    s_mov_b32 s65, s9
    s_mov_b32 s66, 1280
    s_mov_b32 s67, 0x20000
    buffer_load_ushort v18, v32, s[64:67], 0 offen
    s_mov_b32 s64, s18
    s_mov_b32 s65, s19
    s_mov_b32 s66, 1280
    s_mov_b32 s67, 0x20000
    buffer_load_ushort v19, v32, s[64:67], 0 offen
    s_branch K_hj_23
K_hffn_22:
    s_mul_i32 s80, s40, 384
    v_lshl_add_u32 v32, v2, 3, s80
    s_mov_b32 s64, s26
    s_mov_b32 s65, s27
    s_mov_b32 s66, 3456
    s_mov_b32 s67, 0x20000
    buffer_load_dwordx2 v[18:19], v32, s[64:67], 0 offen
K_hj_23:
    s_lshr_b32 s80, s37, 3
    s_lshl_b32 s80, s80, 4
    s_add_u32 s80, s80, s36
    s_mul_i32 s78, s80, 3
    s_lshl_b32 s80, s81, 1
    s_add_u32 s78, s78, s80
    s_add_u32 s79, s78, 1
    s_cmp_eq_u32 s81, 1
    s_cmov_b32 s79, 100
    s_cmp_eq_u32 s96, 0
    s_cbranch_scc1 K_pr_24
    s_lshr_b32 s78, s36, 1
    s_lshl_b32 s78, s78, 2
    s_and_b32 s80, s36, 1
    s_add_u32 s78, s78, s80
    s_add_u32 s78, s78, 54
    s_add_u32 s79, s78, 2
    s_cmp_eq_u32 s81, 0
    s_cbranch_scc1 K_pr_24
    s_mov_b32 s79, 100
    s_cmp_lt_u32 s36, 6
    s_cselect_b32 s78, 48, 80
    s_add_u32 s78, s78, s36
K_pr_24:
    s_and_b32 s84, s78, 1
    s_cmp_eq_u32 s84, 0
    s_cselect_b32 s48, s14, s16
    s_cselect_b32 s49, s15, s17
    s_mov_b32 s50, 819200
    s_mov_b32 s51, 0x20000
    s_sub_u32 s80, s78, 54
    s_lshr_b32 s80, s80, 1
    s_lshl_b32 s80, s80, 6
    s_mul_i32 s84, s97, 102400
    s_add_u32 s44, s80, s84
    s_mul_i32 s80, s78, 40960
    s_mul_i32 s84, s97, 160
    s_add_u32 s80, s80, s84
    s_cmp_lt_u32 s78, 54
    s_cselect_b32 s48, s28, s48
    s_cselect_b32 s49, s29, s49
    s_cmov_b32 s50, 2211840
    s_cselect_b32 s44, s80, s44
    s_and_b32 s84, s79, 1
    s_cmp_eq_u32 s84, 0
    s_cselect_b32 s52, s14, s16
    s_cselect_b32 s53, s15, s17
    s_mov_b32 s54, 819200
    s_mov_b32 s55, 0x20000
    s_sub_u32 s80, s79, 54
    s_lshr_b32 s80, s80, 1
    s_lshl_b32 s80, s80, 6
    s_mul_i32 s84, s97, 102400
    s_add_u32 s45, s80, s84
    s_mul_i32 s80, s79, 40960
    s_mul_i32 s84, s97, 160
    s_add_u32 s80, s80, s84
    s_cmp_lt_u32 s79, 54
    s_cselect_b32 s52, s28, s52
    s_cselect_b32 s53, s29, s53
    s_cmov_b32 s54, 2211840
    s_cselect_b32 s45, s80, s45
    s_mov_b32 s22, s4
    s_mov_b32 s23, s5
    s_lshl_b32 s74, s36, 1
    s_lshr_b32 s16, s38, 1
    s_add_u32 s74, s74, s16
    s_mul_i32 s74, s74, 393216
    s_and_b32 s16, s38, 1
    s_lshl_b32 s16, s16, 11
    s_add_u32 s74, s74, s16
    s_mul_i32 s16, s96, 147456
    s_add_u32 s74, s74, s16
    s_add_u32 s4, s34, s74
    s_addc_u32 s5, s35, 0
    s_mov_b32 s6, 385024
    s_mov_b32 s7, 0x20000
    s_mul_i32 s74, s97, 491520
    s_add_u32 s74, s74, 12582912
    s_mul_i32 s16, s96, 184320
    s_add_u32 s74, s74, s16
    s_add_u32 s8, s34, s74
    s_addc_u32 s9, s35, 0
    s_mov_b32 s10, 481280
    s_mov_b32 s11, 0x20000
    s_cmp_eq_u32 s96, 1
    s_cmov_b32 s6, 196608
    s_cmov_b32 s10, 245760
    s_mov_b32 s12, s30
    s_mov_b32 s13, s31
    s_mov_b32 s14, 5242880
    s_mov_b32 s15, 0x20000
    s_mul_i32 s17, s38, 5120
    v_add_u32 v1, 4096, v7
    s_cmp_eq_u32 s96, 0
    s_cselect_b32 s101, 245760, 0
    s_add_u32 s101, s101, s17
    s_lshl_b32 s74, s36, 3
    s_add_u32 s74, s74, s97
    s_lshl_b32 s19, s74, 7
    s_add_u32 s19, s19, 17694720
    s_lshl_b32 s74, s74, 2
    s_add_u32 s74, s74, s38
    s_mul_i32 s18, s74, 10240
    s_add_u32 s18, s18, 17825792
    v_mov_b32 v20, -1
    v_mov_b32 v21, -1
    v_mov_b32 v22, -1
    v_mov_b32 v23, -1
    s_cmp_eq_u32 s82, 64
    s_cselect_b32 s80, 0x10000, 0
    buffer_store_dwordx4 v[20:23], v7, s[68:71], s80 offen sc1
    s_cmp_eq_u32 s81, 1
    s_cbranch_scc1 K_cl1_25
    s_lshl_b32 s80, s36, 12
    s_lshl_b32 s84, s37, 7
    s_add_u32 s80, s80, s84
    s_add_u32 s80, s80, 17563648
    v_lshrrev_b32 v34, 3, v2
    v_lshl_add_u32 v33, v34, 11, s80
    s_cmp_eq_u32 s96, 0
    s_cselect_b32 s84, s19, 0x7fff0000
    v_mov_b32 v35, s84
    v_cmp_eq_u32 vcc, 2, v34
    s_nop 1
    v_cndmask_b32 v33, v33, v35, vcc
    s_lshl_b32 s84, s36, 4
    s_add_u32 s84, s84, s37
    s_lshl_b32 s84, s84, 7
    s_add_u32 s84, s84, 17498112
    v_mov_b32 v35, s84
    v_cmp_eq_u32 vcc, 3, v34
    s_nop 1
    v_cndmask_b32 v33, v33, v35, vcc
    v_add_u32 v35, 0x8000, v35
    v_cmp_eq_u32 vcc, 4, v34
    s_nop 1
    v_cndmask_b32 v33, v33, v35, vcc
    s_add_u32 s84, s80, 55296
    v_lshl_add_u32 v35, v34, 11, s84
    v_cmp_lt_u32 vcc, 4, v34
    s_nop 1
    v_cndmask_b32 v33, v33, v35, vcc
    v_and_b32 v34, 7, v2
    v_lshl_add_u32 v33, v34, 4, v33
    v_mov_b32 v224, 0
    v_mov_b32 v225, 0
    v_mov_b32 v226, 0
    v_mov_b32 v227, 0
    s_mov_b32 exec_hi, 0xffffff
    buffer_store_dwordx4 v[224:227], v33, s[56:59], 0 offen sc1
    s_branch K_cl2_26
K_cl1_25:
    s_mul_i32 s80, s40, 12288
    s_sub_u32 s84, 15, s36
    s_mul_i32 s84, s84, 768
    s_add_u32 s80, s80, s84
    s_add_u32 s80, s80, 17301504
    s_cmp_eq_u32 s39, 0
    s_cmov_b32 s80, 0x7fff0000
    s_mov_b32 exec_hi, 0xffff
    buffer_store_dwordx4 v[20:23], v7, s[56:59], s80 offen sc1
K_cl2_26:
    s_mov_b64 exec, -1
    v_add_u32 v33, 0, v2
    v_mul_u32_u24 v34, 6554, v33
    v_lshrrev_b32 v34, 16, v34
    v_mul_u32_u24 v34, 1120, v34
    v_lshl_add_u32 v230, v33, 4, v34
    v_add_u32 v33, 64, v2
    v_mul_u32_u24 v34, 6554, v33
    v_lshrrev_b32 v34, 16, v34
    v_mul_u32_u24 v34, 1120, v34
    v_lshl_add_u32 v231, v33, 4, v34
    v_add_u32 v33, 128, v2
    v_mul_u32_u24 v34, 6554, v33
    v_lshrrev_b32 v34, 16, v34
    v_mul_u32_u24 v34, 1120, v34
    v_lshl_add_u32 v232, v33, 4, v34
    v_add_u32 v33, 192, v2
    v_mul_u32_u24 v34, 6554, v33
    v_lshrrev_b32 v34, 16, v34
    v_mul_u32_u24 v34, 1120, v34
    v_lshl_add_u32 v233, v33, 4, v34
    v_add_u32 v33, 256, v2
    v_mul_u32_u24 v34, 6554, v33
    v_lshrrev_b32 v34, 16, v34
    v_mul_u32_u24 v34, 1120, v34
    v_lshl_add_u32 v234, v33, 4, v34
    v_and_b32 v33, 15, v2
    v_mul_u32_u24 v33, 1280, v33
    v_lshrrev_b32 v34, 4, v2
    v_lshl_add_u32 v235, v34, 4, v33
    s_mul_i32 s77, s81, 10240
    s_add_u32 s77, s77, 122880
    v_bfe_u32 v36, v3, 2, 1
    v_lshlrev_b32 v36, 4, v36
    v_and_b32 v37, 1, v3
    v_lshl_add_u32 v36, v37, 3, v36
    v_bfe_u32 v37, v3, 3, 2
    v_lshl_add_u32 v36, v37, 1, v36
    v_bfe_u32 v37, v3, 1, 1
    v_add_u32 v36, v37, v36
    v_cndmask_b32 v36, v3, v36, s[86:87]
    v_lshl_add_u32 v36, v4, 5, v36
    v_lshlrev_b32 v36, 3, v36
    v_and_b32 v38, 19, v3
    v_bfe_u32 v37, v3, 2, 1
    v_lshl_add_u32 v38, v37, 3, v38
    v_bfe_u32 v37, v3, 3, 1
    v_lshl_add_u32 v38, v37, 2, v38
    v_lshl_add_u32 v38, v4, 5, v38
    v_lshlrev_b32 v38, 2, v38
    v_lshlrev_b32 v37, 3, v3
    v_lshl_add_u32 v37, v4, 2, v37
    v_cndmask_b32 v38, v38, v37, s[86:87]
    s_cmp_eq_u32 s81, 1
    s_cselect_b64 vcc, -1, 0
    v_cndmask_b32 v13, v36, v38, vcc
    v_lshrrev_b32 v33, 4, v2
    v_bfe_u32 v34, v2, 2, 2
    v_lshl_add_u32 v33, v33, 3, v34
    v_mul_u32_u24 v33, 160, v33
    v_and_b32 v34, 3, v2
    v_lshl_add_u32 v33, v34, 3, v33
    v_add_u32 v12, s77, v33
    v_mov_b32 v176, 0
    v_mov_b32 v177, 0
    v_mov_b32 v178, 0
    v_mov_b32 v179, 0
    v_mov_b32 v180, 0
    v_mov_b32 v181, 0
    v_mov_b32 v182, 0
    v_mov_b32 v183, 0
    s_mov_b32 s60, s32
    s_mov_b32 s61, s33
    s_mov_b32 s62, 256
    s_mov_b32 s63, 0x20000
    s_getreg_b32 s100, hwreg(HW_REG_XCC_ID, 0, 4)
    s_lshl_b32 s98, s36, 4
    s_add_u32 s98, s98, s37
    s_lshl_b32 s99, s98, 7
    s_add_u32 s99, s99, 17498112
    s_mov_b32 s95, 17498112
    s_lshl_b32 s74, s36, 4
    v_add_u32 v11, s74, v2
    v_and_b32 v34, 31, v2
    v_lshl_add_u32 v34, v34, 3, s97
    v_cmp_gt_u32 vcc, 16, v2
    v_mov_b32 v10, 0
    s_nop 0
    v_cndmask_b32 v11, v34, v11, vcc
    v_lshlrev_b32 v11, 7, v11
    s_sub_u32 s80, s93, 16
    v_min_u32 v15, s80, v7
    s_mov_b32 s72, 0
    s_mov_b32 s73, 0
    s_add_u32 s83, s82, 3
    s_mov_b32 s94, 0xffff0000
K_sloop:
    s_barrier
    s_sub_u32 s84, s72, s82
    s_cmp_ge_u32 s84, 4
    s_cbranch_scc1 K_sa_27
    s_lshl_b32 s85, s84, 5
    v_xor_b32 v31, s85, v5
    v_add_u32 v31, s73, v31
    s_cmp_eq_u32 s81, 1
    s_cbranch_scc1 K_sac_31
    ds_read_b128 v[40:43], v31 offset:0
    ds_read_b128 v[44:47], v31 offset:4096
    ds_read_b128 v[48:51], v31 offset:8192
    ds_read_b128 v[52:55], v31 offset:12288
    s_waitcnt lgkmcnt(0)
    v_lshlrev_b32 v64, 16, v40
    v_and_b32 v65, s94, v40
    v_lshlrev_b32 v66, 16, v44
    v_and_b32 v67, s94, v44
    v_lshlrev_b32 v68, 16, v48
    v_and_b32 v69, s94, v48
    v_lshlrev_b32 v70, 16, v52
    v_and_b32 v71, s94, v52
    v_add_f32 v176, v176, v64
    v_fmac_f32 v180, v64, v64
    v_add_f32 v177, v177, v66
    v_fmac_f32 v181, v66, v66
    v_add_f32 v178, v178, v68
    v_fmac_f32 v182, v68, v68
    v_add_f32 v179, v179, v70
    v_fmac_f32 v183, v70, v70
    v_add_f32 v176, v176, v65
    v_fmac_f32 v180, v65, v65
    v_add_f32 v177, v177, v67
    v_fmac_f32 v181, v67, v67
    v_add_f32 v178, v178, v69
    v_fmac_f32 v182, v69, v69
    v_add_f32 v179, v179, v71
    v_fmac_f32 v183, v71, v71
    v_lshlrev_b32 v64, 16, v41
    v_and_b32 v65, s94, v41
    v_lshlrev_b32 v66, 16, v45
    v_and_b32 v67, s94, v45
    v_lshlrev_b32 v68, 16, v49
    v_and_b32 v69, s94, v49
    v_lshlrev_b32 v70, 16, v53
    v_and_b32 v71, s94, v53
    v_add_f32 v176, v176, v64
    v_fmac_f32 v180, v64, v64
    v_add_f32 v177, v177, v66
    v_fmac_f32 v181, v66, v66
    v_add_f32 v178, v178, v68
    v_fmac_f32 v182, v68, v68
    v_add_f32 v179, v179, v70
    v_fmac_f32 v183, v70, v70
    v_add_f32 v176, v176, v65
    v_fmac_f32 v180, v65, v65
    v_add_f32 v177, v177, v67
    v_fmac_f32 v181, v67, v67
    v_add_f32 v178, v178, v69
    v_fmac_f32 v182, v69, v69
    v_add_f32 v179, v179, v71
    v_fmac_f32 v183, v71, v71
    v_lshlrev_b32 v64, 16, v42
    v_and_b32 v65, s94, v42
    v_lshlrev_b32 v66, 16, v46
    v_and_b32 v67, s94, v46
    v_lshlrev_b32 v68, 16, v50
    v_and_b32 v69, s94, v50
    v_lshlrev_b32 v70, 16, v54
    v_and_b32 v71, s94, v54
    v_add_f32 v176, v176, v64
    v_fmac_f32 v180, v64, v64
    v_add_f32 v177, v177, v66
    v_fmac_f32 v181, v66, v66
    v_add_f32 v178, v178, v68
    v_fmac_f32 v182, v68, v68
    v_add_f32 v179, v179, v70
    v_fmac_f32 v183, v70, v70
    v_add_f32 v176, v176, v65
    v_fmac_f32 v180, v65, v65
    v_add_f32 v177, v177, v67
    v_fmac_f32 v181, v67, v67
    v_add_f32 v178, v178, v69
    v_fmac_f32 v182, v69, v69
    v_add_f32 v179, v179, v71
    v_fmac_f32 v183, v71, v71
    v_lshlrev_b32 v64, 16, v43
    v_and_b32 v65, s94, v43
    v_lshlrev_b32 v66, 16, v47
    v_and_b32 v67, s94, v47
    v_lshlrev_b32 v68, 16, v51
    v_and_b32 v69, s94, v51
    v_lshlrev_b32 v70, 16, v55
    v_and_b32 v71, s94, v55
    v_add_f32 v176, v176, v64
    v_fmac_f32 v180, v64, v64
    v_add_f32 v177, v177, v66
    v_fmac_f32 v181, v66, v66
    v_add_f32 v178, v178, v68
    v_fmac_f32 v182, v68, v68
    v_add_f32 v179, v179, v70
    v_fmac_f32 v183, v70, v70
    v_add_f32 v176, v176, v65
    v_fmac_f32 v180, v65, v65
    v_add_f32 v177, v177, v67
    v_fmac_f32 v181, v67, v67
    v_add_f32 v178, v178, v69
    v_fmac_f32 v182, v69, v69
    v_add_f32 v179, v179, v71
    v_fmac_f32 v183, v71, v71
    s_branch K_sa_27
K_sac_31:
    s_cmp_eq_u32 s39, 0
    s_cbranch_scc1 K_sacf_32
    ds_read_b128 v[40:43], v31 offset:16384
    ds_read_b128 v[44:47], v31 offset:20480
    ds_read_b128 v[48:51], v31 offset:24576
    ds_read_b128 v[52:55], v31 offset:28672
    ds_read_b128 v[56:59], v31 offset:32768
    ds_read_b128 v[60:63], v31 offset:36864
    s_branch K_sacd_33
K_sacf_32:
    s_lshl_b32 s85, s84, 11
    s_add_u32 s85, s85, s73
    v_add_u32 v31, s85, v6
    v_xor_b32 v38, 64, v31
    ds_read_b64_tr_b16 v[40:41], v31 offset:16384
    ds_read_b64_tr_b16 v[42:43], v31 offset:16896
    ds_read_b64_tr_b16 v[44:45], v38 offset:16384
    ds_read_b64_tr_b16 v[46:47], v38 offset:16896
    ds_read_b64_tr_b16 v[48:49], v31 offset:24576
    ds_read_b64_tr_b16 v[50:51], v31 offset:25088
    ds_read_b64_tr_b16 v[52:53], v38 offset:24576
    ds_read_b64_tr_b16 v[54:55], v38 offset:25088
    ds_read_b64_tr_b16 v[56:57], v31 offset:32768
    ds_read_b64_tr_b16 v[58:59], v31 offset:33280
    ds_read_b64_tr_b16 v[60:61], v38 offset:32768
    ds_read_b64_tr_b16 v[62:63], v38 offset:33280
K_sacd_33:
    s_waitcnt lgkmcnt(0)
    v_lshlrev_b32 v64, 16, v40
    v_and_b32 v65, s94, v40
    v_lshlrev_b32 v66, 16, v44
    v_and_b32 v67, s94, v44
    v_lshlrev_b32 v68, 16, v48
    v_and_b32 v69, s94, v48
    v_lshlrev_b32 v70, 16, v52
    v_and_b32 v71, s94, v52
    v_lshlrev_b32 v72, 16, v56
    v_and_b32 v73, s94, v56
    v_lshlrev_b32 v74, 16, v60
    v_and_b32 v75, s94, v60
    v_add_f32 v176, v176, v64
    v_add_f32 v177, v177, v66
    v_add_f32 v178, v178, v68
    v_add_f32 v179, v179, v70
    v_add_f32 v180, v180, v72
    v_add_f32 v181, v181, v74
    v_add_f32 v176, v176, v65
    v_add_f32 v177, v177, v67
    v_add_f32 v178, v178, v69
    v_add_f32 v179, v179, v71
    v_add_f32 v180, v180, v73
    v_add_f32 v181, v181, v75
    v_lshlrev_b32 v64, 16, v41
    v_and_b32 v65, s94, v41
    v_lshlrev_b32 v66, 16, v45
    v_and_b32 v67, s94, v45
    v_lshlrev_b32 v68, 16, v49
    v_and_b32 v69, s94, v49
    v_lshlrev_b32 v70, 16, v53
    v_and_b32 v71, s94, v53
    v_lshlrev_b32 v72, 16, v57
    v_and_b32 v73, s94, v57
    v_lshlrev_b32 v74, 16, v61
    v_and_b32 v75, s94, v61
    v_add_f32 v176, v176, v64
    v_add_f32 v177, v177, v66
    v_add_f32 v178, v178, v68
    v_add_f32 v179, v179, v70
    v_add_f32 v180, v180, v72
    v_add_f32 v181, v181, v74
    v_add_f32 v176, v176, v65
    v_add_f32 v177, v177, v67
    v_add_f32 v178, v178, v69
    v_add_f32 v179, v179, v71
    v_add_f32 v180, v180, v73
    v_add_f32 v181, v181, v75
    v_lshlrev_b32 v64, 16, v42
    v_and_b32 v65, s94, v42
    v_lshlrev_b32 v66, 16, v46
    v_and_b32 v67, s94, v46
    v_lshlrev_b32 v68, 16, v50
    v_and_b32 v69, s94, v50
    v_lshlrev_b32 v70, 16, v54
    v_and_b32 v71, s94, v54
    v_lshlrev_b32 v72, 16, v58
    v_and_b32 v73, s94, v58
    v_lshlrev_b32 v74, 16, v62
    v_and_b32 v75, s94, v62
    v_add_f32 v176, v176, v64
    v_add_f32 v177, v177, v66
    v_add_f32 v178, v178, v68
    v_add_f32 v179, v179, v70
    v_add_f32 v180, v180, v72
    v_add_f32 v181, v181, v74
    v_add_f32 v176, v176, v65
    v_add_f32 v177, v177, v67
    v_add_f32 v178, v178, v69
    v_add_f32 v179, v179, v71
    v_add_f32 v180, v180, v73
    v_add_f32 v181, v181, v75
    v_lshlrev_b32 v64, 16, v43
    v_and_b32 v65, s94, v43
    v_lshlrev_b32 v66, 16, v47
    v_and_b32 v67, s94, v47
    v_lshlrev_b32 v68, 16, v51
    v_and_b32 v69, s94, v51
    v_lshlrev_b32 v70, 16, v55
    v_and_b32 v71, s94, v55
    v_lshlrev_b32 v72, 16, v59
    v_and_b32 v73, s94, v59
    v_lshlrev_b32 v74, 16, v63
    v_and_b32 v75, s94, v63
    v_add_f32 v176, v176, v64
    v_add_f32 v177, v177, v66
    v_add_f32 v178, v178, v68
    v_add_f32 v179, v179, v70
    v_add_f32 v180, v180, v72
    v_add_f32 v181, v181, v74
    v_add_f32 v176, v176, v65
    v_add_f32 v177, v177, v67
    v_add_f32 v178, v178, v69
    v_add_f32 v179, v179, v71
    v_add_f32 v180, v180, v73
    v_add_f32 v181, v181, v75
K_sa_27:
    s_cmp_lg_u32 s72, 0
    s_cbranch_scc1 K_nc_35
    s_cmp_eq_u32 s39, 0
    s_cbranch_scc1 K_nc_35
    s_waitcnt vmcnt(2)
    v_lshlrev_b32 v17, 16, v17
    v_lshlrev_b32 v18, 16, v18
    v_lshlrev_b32 v19, 16, v19
    v_mul_f32 v19, 1069066811, v19
    v_exp_f32 v19, v19
    s_nop 0
    v_cvt_pk_bf16_f32 v19, v19, v19
    v_lshlrev_b32 v19, 16, v19
    v_mul_f32 v32, v19, v17
    v_mul_f32 v33, v19, v18
    v_mul_f32 v32, 1069066811, v32
    v_exp_f32 v32, v32
    v_mul_f32 v33, 0.15915494, v33
    v_fract_f32 v33, v33
    v_cos_f32 v34, v33
    v_sin_f32 v35, v33
    s_nop 0
    v_mul_f32 v20, v32, v34
    v_mul_f32 v21, v32, v35
    v_add_f32 v32, -1.0, v20
    v_mul_f32 v33, v17, v17
    v_fmac_f32 v33, v18, v18
    v_rcp_f32 v33, v33
    v_mul_f32 v34, v32, v17
    v_fmac_f32 v34, v21, v18
    v_mul_f32 v35, v21, v17
    v_fma_f32 v35, -v32, v18, v35
    v_add_f32 v33, v33, v33
    v_mul_f32 v22, v34, v33
    v_mul_f32 v23, v35, v33
    v_mul_f32 v32, v21, v21
    v_mul_f32 v33, v20, v21
    v_fma_f32 v28, v20, v20, -v32
    v_add_f32 v29, v33, v33
    v_mul_f32 v32, v29, v29
    v_mul_f32 v33, v28, v29
    v_fma_f32 v26, v28, v28, -v32
    v_add_f32 v27, v33, v33
    v_mul_f32 v32, v27, v27
    v_mul_f32 v33, v26, v27
    v_fma_f32 v24, v26, v26, -v32
    v_add_f32 v25, v33, v33
    v_mul_f32 v32, v25, v25
    v_mul_f32 v33, v24, v25
    v_fma_f32 v28, v24, v24, -v32
    v_add_f32 v29, v33, v33
    v_mul_f32 v32, v29, v29
    v_mul_f32 v33, v28, v29
    v_fma_f32 v26, v28, v28, -v32
    v_add_f32 v27, v33, v33
    v_mul_f32 v32, v27, v27
    v_mul_f32 v33, v26, v27
    v_fma_f32 v34, v26, v26, -v32
    v_add_f32 v35, v33, v33
    v_mul_f32 v32, v35, v35
    v_mul_f32 v33, v34, v35
    v_fma_f32 v26, v34, v34, -v32
    v_add_f32 v27, v33, v33
    v_cmp_gt_u32 vcc, 96, v14
    s_and_saveexec_b64 s[88:89], vcc
    v_lshlrev_b32 v32, 5, v14
    v_add_u32 v32, 144384, v32
    ds_write_b128 v32, v[20:23]
    ds_write_b64 v32, v[24:25] offset:16
    s_mov_b64 exec, -1
K_nc_35:
    s_cmp_lg_u32 s72, 0
    s_cbranch_scc1 K_srl_36
    s_cmp_ge_u32 s78, 94
    s_cbranch_scc1 K_rd_38
    s_cmp_ge_u32 s78, 54
    s_cbranch_scc1 K_rc_37
    s_add_u32 m0, s77, 0
    s_nop 0
    buffer_load_dwordx4 v230, s[48:51], s44 offen nt lds
    s_add_u32 m0, s77, 1024
    s_nop 0
    buffer_load_dwordx4 v231, s[48:51], s44 offen nt lds
    s_add_u32 m0, s77, 2048
    s_nop 0
    buffer_load_dwordx4 v232, s[48:51], s44 offen nt lds
    s_add_u32 m0, s77, 3072
    s_nop 0
    buffer_load_dwordx4 v233, s[48:51], s44 offen nt lds
    s_add_u32 m0, s77, 4096
    s_nop 0
    buffer_load_dwordx4 v234, s[48:51], s44 offen nt lds
    s_branch K_rd_38
K_rc_37:
    buffer_load_dwordx4 v[136:139], v235, s[48:51], s44 offen nt
    s_add_u32 s44, s44, 20480
    buffer_load_dwordx4 v[140:143], v235, s[48:51], s44 offen nt
    s_add_u32 s44, s44, 20480
    buffer_load_dwordx4 v[144:147], v235, s[48:51], s44 offen nt
    s_add_u32 s44, s44, 20480
    buffer_load_dwordx4 v[148:151], v235, s[48:51], s44 offen nt
    s_add_u32 s44, s44, 20480
    buffer_load_dwordx4 v[152:155], v235, s[48:51], s44 offen nt
    s_add_u32 s44, s44, 20480
K_rd_38:
    s_cmp_ge_u32 s79, 94
    s_cbranch_scc1 K_rd_40
    s_cmp_ge_u32 s79, 54
    s_cbranch_scc1 K_rc_39
    s_add_u32 m0, s77, 5120
    s_nop 0
    buffer_load_dwordx4 v230, s[52:55], s45 offen nt lds
    s_add_u32 m0, s77, 6144
    s_nop 0
    buffer_load_dwordx4 v231, s[52:55], s45 offen nt lds
    s_add_u32 m0, s77, 7168
    s_nop 0
    buffer_load_dwordx4 v232, s[52:55], s45 offen nt lds
    s_add_u32 m0, s77, 8192
    s_nop 0
    buffer_load_dwordx4 v233, s[52:55], s45 offen nt lds
    s_add_u32 m0, s77, 9216
    s_nop 0
    buffer_load_dwordx4 v234, s[52:55], s45 offen nt lds
    s_branch K_rd_40
K_rc_39:
    buffer_load_dwordx4 v[156:159], v235, s[52:55], s45 offen nt
    s_add_u32 s45, s45, 20480
    buffer_load_dwordx4 v[160:163], v235, s[52:55], s45 offen nt
    s_add_u32 s45, s45, 20480
    buffer_load_dwordx4 v[164:167], v235, s[52:55], s45 offen nt
    s_add_u32 s45, s45, 20480
    buffer_load_dwordx4 v[168:171], v235, s[52:55], s45 offen nt
    s_add_u32 s45, s45, 20480
    buffer_load_dwordx4 v[172:175], v235, s[52:55], s45 offen nt
    s_add_u32 s45, s45, 20480
K_rd_40:
K_srl_36:
    s_cmp_lg_u32 s72, 1
    s_cbranch_scc1 K_se_41
    buffer_load_dwordx2 v[8:9], v10, s[60:63], 0 offen sc1
K_se_41:
    s_cmp_lg_u32 s72, 2
    s_cbranch_scc1 K_sd_30
    s_mov_b32 s80, 131072
K_sn_43:
    s_waitcnt vmcnt(0)
    v_cmp_eq_u32 vcc, 0, v9
    s_cbranch_vccz K_sd_30
    s_sleep 4
    buffer_load_dwordx2 v[8:9], v10, s[60:63], 0 offen sc1
    s_sub_u32 s80, s80, 1
    s_cmp_lg_u32 s80, 0
    s_cbranch_scc1 K_sn_43
K_sd_30:
    s_cmp_lg_u32 s72, 3
    s_cbranch_scc1 K_sf_42
    s_cmp_lg_u32 s81, 0
    s_cbranch_scc1 K_sf_42
    v_mov_b32 v220, v8
    v_mov_b32 v221, v9
    v_mov_b32 v222, s100
    v_mov_b32 v223, v8
    s_mov_b64 exec, 1
    buffer_store_dwordx4 v[220:223], v10, s[56:59], s99 offen sc1
    s_mov_b64 exec, -1
K_sf_42:
    s_cmp_lg_u32 s72, 2
    s_cbranch_scc1 K_nor_45
    s_waitcnt vmcnt(0)
    s_cmp_ge_u32 s78, 94
    s_cbranch_scc1 K_nor_45
    s_cmp_ge_u32 s78, 54
    s_cbranch_scc1 K_np_46
    ds_read_b64_tr_b16 v[136:137], v12 offset:0
    ds_read_b64_tr_b16 v[138:139], v12 offset:640
    ds_read_b64_tr_b16 v[140:141], v12 offset:32
    ds_read_b64_tr_b16 v[142:143], v12 offset:672
    ds_read_b64_tr_b16 v[144:145], v12 offset:64
    ds_read_b64_tr_b16 v[146:147], v12 offset:704
    ds_read_b64_tr_b16 v[148:149], v12 offset:96
    ds_read_b64_tr_b16 v[150:151], v12 offset:736
    ds_read_b64_tr_b16 v[152:153], v12 offset:128
    ds_read_b64_tr_b16 v[154:155], v12 offset:768
    s_waitcnt lgkmcnt(0)
K_np_46:
    s_mul_i32 s84, s97, 491520
    s_mul_i32 s85, s78, 5120
    s_add_u32 s84, s84, s85
    s_add_u32 s84, s84, 12582912
    s_add_u32 s85, s84, 4096
    buffer_store_dwordx4 v[136:139], v7, s[56:59], s84 offen offset:0 sc1
    buffer_store_dwordx4 v[140:143], v7, s[56:59], s84 offen offset:1024 sc1
    buffer_store_dwordx4 v[144:147], v7, s[56:59], s84 offen offset:2048 sc1
    buffer_store_dwordx4 v[148:151], v7, s[56:59], s84 offen offset:3072 sc1
    buffer_store_dwordx4 v[152:155], v7, s[56:59], s85 offen sc1
K_nor_45:
    s_cmp_lg_u32 s72, 2
    s_cbranch_scc1 K_nor_47
    s_cmp_ge_u32 s79, 94
    s_cbranch_scc1 K_nor_47
    s_cmp_ge_u32 s79, 54
    s_cbranch_scc1 K_np_48
    ds_read_b64_tr_b16 v[156:157], v12 offset:5120
    ds_read_b64_tr_b16 v[158:159], v12 offset:5760
    ds_read_b64_tr_b16 v[160:161], v12 offset:5152
    ds_read_b64_tr_b16 v[162:163], v12 offset:5792
    ds_read_b64_tr_b16 v[164:165], v12 offset:5184
    ds_read_b64_tr_b16 v[166:167], v12 offset:5824
    ds_read_b64_tr_b16 v[168:169], v12 offset:5216
    ds_read_b64_tr_b16 v[170:171], v12 offset:5856
    ds_read_b64_tr_b16 v[172:173], v12 offset:5248
    ds_read_b64_tr_b16 v[174:175], v12 offset:5888
    s_waitcnt lgkmcnt(0)
K_np_48:
    s_mul_i32 s84, s97, 491520
    s_mul_i32 s85, s79, 5120
    s_add_u32 s84, s84, s85
    s_add_u32 s84, s84, 12582912
    s_add_u32 s85, s84, 4096
    buffer_store_dwordx4 v[156:159], v7, s[56:59], s84 offen offset:0 sc1
    buffer_store_dwordx4 v[160:163], v7, s[56:59], s84 offen offset:1024 sc1
    buffer_store_dwordx4 v[164:167], v7, s[56:59], s84 offen offset:2048 sc1
    buffer_store_dwordx4 v[168:171], v7, s[56:59], s84 offen offset:3072 sc1
    buffer_store_dwordx4 v[172:175], v7, s[56:59], s85 offen sc1
K_nor_47:
K_sc_29:
    s_cmp_lg_u32 s72, 4
    s_cbranch_scc1 K_rq_49
    s_waitcnt vmcnt(0)
K_rq_49:
    s_cmp_lg_u32 s72, 5
    s_cbranch_scc1 K_rr_50
    s_cmp_lg_u32 s81, 0
    s_cbranch_scc1 K_rr_50
    s_add_u32 s80, s99, 0x8000
    v_mov_b32 v32, 160776
    ds_write_b64 v32, v[8:9]
    s_waitcnt lgkmcnt(0)
    s_mov_b64 exec, 1
    buffer_store_dwordx2 v[8:9], v10, s[56:59], s80 offen sc1
    s_mov_b64 exec, -1
K_rr_50:
    s_cmp_lg_u32 s72, s83
    s_cbranch_scc1 K_sb_28
    s_cmp_eq_u32 s81, 1
    s_cbranch_scc1 K_sbc_34
    s_nop 3
    v_permlane32_swap_b32 v176, v177
    v_permlane32_swap_b32 v178, v179
    v_permlane32_swap_b32 v180, v181
    v_permlane32_swap_b32 v182, v183
    s_nop 1
    v_add_f32 v176, v176, v177
    v_add_f32 v177, v180, v181
    v_add_f32 v178, v178, v179
    v_add_f32 v179, v182, v183
    v_min_u32 v176, -2, v176
    v_min_u32 v177, -2, v177
    v_min_u32 v178, -2, v178
    v_min_u32 v179, -2, v179
    buffer_store_dwordx2 v[176:177], v13, s[68:71], 0 offen sc1
    buffer_store_dwordx2 v[178:179], v13, s[68:71], 0 offen offset:512 sc1
    s_branch K_sb_28
K_sbc_34:
    s_nop 3
    v_permlane32_swap_b32 v176, v177
    v_permlane32_swap_b32 v178, v179
    v_permlane32_swap_b32 v180, v181
    s_nop 1
    v_add_f32 v176, v176, v177
    v_min_u32 v176, -2, v176
    buffer_store_dword v176, v13, s[68:71], 0 offen offset:0 sc1
    v_add_f32 v178, v178, v179
    v_min_u32 v178, -2, v178
    buffer_store_dword v178, v13, s[68:71], 0 offen offset:256 sc1
    v_add_f32 v180, v180, v181
    v_min_u32 v180, -2, v180
    buffer_store_dword v180, v13, s[68:71], 0 offen offset:512 sc1
K_sb_28:
    s_add_u32 s72, s72, 1
    s_add_u32 s73, s73, 40960
    s_cmp_eq_u32 s73, 122880
    s_cselect_b32 s73, 0, s73
    s_cmp_lt_u32 s72, 6
    s_cbranch_scc1 K_sloop
    buffer_load_dwordx4 v[216:219], v11, s[56:59], s95 offen sc1
    s_barrier
    v_and_b32 v32, 48, v2
    v_lshlrev_b32 v32, 1, v32
    v_and_b32 v33, 3, v2
    v_lshl_add_u32 v32, v33, 3, v32
    v_bfe_u32 v33, v2, 3, 1
    v_lshl_add_u32 v32, v33, 2, v32
    v_bfe_u32 v33, v2, 2, 1
    v_add_u32 v32, v32, v33
    v_lshlrev_b32 v32, 2, v32
    v_add_u32 v13, 143360, v32
    v_add_u32 v12, 143360, v7
    s_cmp_eq_u32 s81, 0
    s_cbranch_scc1 K_fa_53
    v_add_u32 v12, 144384, v7
    v_lshlrev_b32 v13, 6, v2
    v_add_u32 v13, 144384, v13
    v_lshlrev_b32 v64, 16, v18
    v_and_b32 v65, 0xffff0000, v18
    v_lshlrev_b32 v66, 16, v19
    v_and_b32 v67, 0xffff0000, v19
    v_mul_f32 v64, 1069066811, v64
    v_mul_f32 v65, 1069066811, v65
    v_mul_f32 v66, 1069066811, v66
    v_mul_f32 v67, 1069066811, v67
    s_cmp_eq_u32 s39, 1
    s_cbranch_scc1 K_fa_53
    s_mov_b32 exec_hi, 0xffff
    ds_write_b128 v12, v[64:67] offset:768
    s_mov_b64 exec, -1
K_fa_53:
    s_barrier
    s_mov_b32 s84, 131072
K_f1re_52:
    s_waitcnt vmcnt(0)
    v_xor_b32 v216, v216, v8
    v_xor_b32 v217, v217, v9
    v_xor_b32 v219, v219, v8
    v_or3_b32 v216, v216, v217, v219
    v_cmp_ne_u32 vcc, 0, v216
    s_cbranch_vccz K_f1ok_51
    s_sleep 2
    buffer_load_dwordx4 v[216:219], v11, s[56:59], s95 offen sc1
    s_sub_u32 s84, s84, 1
    s_cmp_lg_u32 s84, 0
    s_cbranch_scc1 K_f1re_52
K_f1ok_51:
    v_cmp_ne_u32 vcc, s100, v218
    s_nop 1
    s_lshl_b32 s85, s96, 3
    s_lshr_b32 s80, vcc_lo, s85
    s_and_b32 s80, s80, 0xff
    s_cmp_eq_u32 s80, 0
    s_cselect_b32 s80, 1, 0
    s_and_b32 s85, vcc_lo, 0xffff
    s_cmp_eq_u32 s85, 0
    s_cselect_b32 s80, 3, s80
    v_mov_b32 v32, s80
    v_mov_b32 v33, 160768
    ds_write_b32 v33, v32
    ds_write_b32 v33, v10 offset:4
    s_barrier
    s_mov_b32 s80, s92
    buffer_load_dwordx4 v[176:179], v15, s[56:59], s80 offen sc1
    s_add_u32 s80, s80, s93
    buffer_load_dwordx4 v[180:183], v15, s[56:59], s80 offen sc1
    s_add_u32 s80, s80, s93
    buffer_load_dwordx4 v[184:187], v15, s[56:59], s80 offen sc1
    s_add_u32 s80, s80, s93
    buffer_load_dwordx4 v[188:191], v15, s[56:59], s80 offen sc1
    s_add_u32 s80, s80, s93
    buffer_load_dwordx4 v[192:195], v15, s[56:59], s80 offen sc1
    s_add_u32 s80, s80, s93
    buffer_load_dwordx4 v[196:199], v15, s[56:59], s80 offen sc1
    s_add_u32 s80, s80, s93
    buffer_load_dwordx4 v[200:203], v15, s[56:59], s80 offen sc1
    s_add_u32 s80, s80, s93
    buffer_load_dwordx4 v[204:207], v15, s[56:59], s80 offen sc1
    s_add_u32 s80, s80, s93
    buffer_load_dwordx4 v[208:211], v15, s[56:59], s80 offen sc1
    s_add_u32 s80, s80, s93
    buffer_load_dwordx4 v[212:215], v15, s[56:59], s80 offen sc1
    s_add_u32 s80, s80, s93
    s_barrier
    s_mov_b32 s84, 131072
    s_mov_b32 s85, 0x3acccccd
K_ga_54:
    s_waitcnt vmcnt(8)
    v_add_f32 v40, v176, v180
    v_add_f32 v41, v177, v181
    v_add_f32 v42, v178, v182
    v_add_f32 v43, v179, v183
    s_waitcnt vmcnt(6)
    v_add_f32 v44, v184, v188
    v_add_f32 v45, v185, v189
    v_add_f32 v46, v186, v190
    v_add_f32 v47, v187, v191
    s_waitcnt vmcnt(4)
    v_add_f32 v48, v192, v196
    v_add_f32 v49, v193, v197
    v_add_f32 v50, v194, v198
    v_add_f32 v51, v195, v199
    s_waitcnt vmcnt(2)
    v_add_f32 v52, v200, v204
    v_add_f32 v53, v201, v205
    v_add_f32 v54, v202, v206
    v_add_f32 v55, v203, v207
    s_waitcnt vmcnt(0)
    v_add_f32 v56, v208, v212
    v_add_f32 v57, v209, v213
    v_add_f32 v58, v210, v214
    v_add_f32 v59, v211, v215
    v_add_f32 v40, v40, v44
    v_add_f32 v48, v48, v52
    v_add_f32 v41, v41, v45
    v_add_f32 v49, v49, v53
    v_add_f32 v42, v42, v46
    v_add_f32 v50, v50, v54
    v_add_f32 v43, v43, v47
    v_add_f32 v51, v51, v55
    v_add_f32 v40, v40, v56
    v_add_f32 v41, v41, v57
    v_add_f32 v42, v42, v58
    v_add_f32 v43, v43, v59
    v_add_f32 v40, v40, v48
    v_add_f32 v41, v41, v49
    v_add_f32 v42, v42, v50
    v_add_f32 v43, v43, v51
    v_add_f32 v44, v40, v41
    v_add_f32 v45, v42, v43
    v_cmp_u_f32 vcc, v44, v45
    s_cbranch_vccnz K_ga_54s
K_gaok_55:
    s_barrier
    s_cmp_eq_u32 s81, 1
    s_cbranch_scc1 K_fc_56
    v_mul_f32 v40, s85, v40
    v_mul_f32 v41, s85, v41
    v_mul_f32 v42, s85, v42
    v_mul_f32 v43, s85, v43
    v_fma_f32 v41, -v40, v40, v41
    v_fma_f32 v43, -v42, v42, v43
    v_max_f32 v41, 0, v41
    v_max_f32 v43, 0, v43
    v_cvt_pk_bf16_f32 v40, v40, v41
    v_cvt_pk_bf16_f32 v42, v42, v43
    v_and_b32 v41, s94, v40
    v_lshlrev_b32 v40, 16, v40
    v_and_b32 v43, s94, v42
    v_lshlrev_b32 v42, 16, v42
    v_add_f32 v41, 0x3727c5ac, v41
    v_add_f32 v43, 0x3727c5ac, v43
    v_cvt_pk_bf16_f32 v44, v41, v43
    v_lshlrev_b32 v41, 16, v44
    v_and_b32 v43, s94, v44
    v_sqrt_f32 v41, v41
    v_sqrt_f32 v43, v43
    s_nop 0
    v_cvt_pk_bf16_f32 v44, v41, v43
    v_lshlrev_b32 v41, 16, v44
    v_and_b32 v43, s94, v44
    v_rcp_f32 v41, v41
    v_rcp_f32 v43, v43
    s_cmp_eq_u32 s39, 1
    s_cbranch_scc1 K_fs_58
    v_mul_f32 v44, v40, v41
    v_mul_f32 v45, 1069066811, v41
    v_mul_f32 v46, v42, v43
    v_mul_f32 v47, 1069066811, v43
    ds_write_b128 v12, v[44:47]
    ds_write_b128 v12, v[40:43] offset:4096
    s_branch K_fd_57
K_fs_58:
    ds_write2_b32 v13, v40, v42 offset0:0 offset1:2
    ds_write2_b32 v13, v41, v43 offset0:128 offset1:130
    ds_write_b128 v12, v[40:43] offset:4096
    s_branch K_fd_57
K_ga_54s:
    v_max_u32 v32, v176, v177
    v_max3_u32 v32, v178, v179, v32
    v_max3_u32 v32, v180, v181, v32
    v_max3_u32 v32, v182, v183, v32
    v_max3_u32 v32, v184, v185, v32
    v_max3_u32 v32, v186, v187, v32
    v_max3_u32 v32, v188, v189, v32
    v_max3_u32 v32, v190, v191, v32
    v_max3_u32 v32, v192, v193, v32
    v_max3_u32 v32, v194, v195, v32
    v_max3_u32 v32, v196, v197, v32
    v_max3_u32 v32, v198, v199, v32
    v_max3_u32 v32, v200, v201, v32
    v_max3_u32 v32, v202, v203, v32
    v_max3_u32 v32, v204, v205, v32
    v_max3_u32 v32, v206, v207, v32
    v_max3_u32 v32, v208, v209, v32
    v_max3_u32 v32, v210, v211, v32
    v_max3_u32 v32, v212, v213, v32
    v_max3_u32 v32, v214, v215, v32
    v_cmp_eq_u32 vcc, -1, v32
    s_cbranch_vccz K_gaok_55
    s_sub_u32 s84, s84, 1
    s_cmp_eq_u32 s84, 0
    s_cbranch_scc1 K_gaok_55
    s_mov_b32 s80, s92
    buffer_load_dwordx4 v[176:179], v15, s[56:59], s80 offen sc1
    s_add_u32 s80, s80, s93
    buffer_load_dwordx4 v[180:183], v15, s[56:59], s80 offen sc1
    s_add_u32 s80, s80, s93
    buffer_load_dwordx4 v[184:187], v15, s[56:59], s80 offen sc1
    s_add_u32 s80, s80, s93
    buffer_load_dwordx4 v[188:191], v15, s[56:59], s80 offen sc1
    s_add_u32 s80, s80, s93
    buffer_load_dwordx4 v[192:195], v15, s[56:59], s80 offen sc1
    s_add_u32 s80, s80, s93
    buffer_load_dwordx4 v[196:199], v15, s[56:59], s80 offen sc1
    s_add_u32 s80, s80, s93
    buffer_load_dwordx4 v[200:203], v15, s[56:59], s80 offen sc1
    s_add_u32 s80, s80, s93
    buffer_load_dwordx4 v[204:207], v15, s[56:59], s80 offen sc1
    s_add_u32 s80, s80, s93
    buffer_load_dwordx4 v[208:211], v15, s[56:59], s80 offen sc1
    s_add_u32 s80, s80, s93
    buffer_load_dwordx4 v[212:215], v15, s[56:59], s80 offen sc1
    s_add_u32 s80, s80, s93
    s_branch K_ga_54
K_fc_56:
    s_mov_b32 exec_hi, 0xffff
    s_cmp_eq_u32 s39, 1
    s_cbranch_scc1 K_fcs_59
    v_mul_f32 v40, 1069066811, v40
    v_mul_f32 v41, 1069066811, v41
    v_mul_f32 v42, 1069066811, v42
    v_mul_f32 v43, 1069066811, v43
    ds_write_b128 v12, v[40:43]
    s_branch K_fd_57
K_fcs_59:
    ds_write_b64 v13, v[40:41] offset:24
    ds_write_b64 v13, v[42:43] offset:56
K_fd_57:
    s_mov_b64 exec, -1
    s_waitcnt lgkmcnt(0)
    s_barrier
    s_add_u32 s80, s17, 163840
    buffer_load_dwordx4 v[36:39], v7, s[8:11], s80 offen offset:0 sc1
    buffer_load_dwordx4 v[40:43], v7, s[8:11], s80 offen offset:1024 sc1
    buffer_load_dwordx4 v[44:47], v7, s[8:11], s80 offen offset:2048 sc1
    buffer_load_dwordx4 v[48:51], v7, s[8:11], s80 offen offset:3072 sc1
    buffer_load_dwordx4 v[52:55], v1, s[8:11], s80 offen sc1
    s_add_u32 s80, s101, 184320
    buffer_load_dwordx4 v[56:59], v7, s[8:11], s80 offen offset:0 sc1
    buffer_load_dwordx4 v[60:63], v7, s[8:11], s80 offen offset:1024 sc1
    buffer_load_dwordx4 v[64:67], v7, s[8:11], s80 offen offset:2048 sc1
    buffer_load_dwordx4 v[68:71], v7, s[8:11], s80 offen offset:3072 sc1
    buffer_load_dwordx4 v[72:75], v1, s[8:11], s80 offen sc1
    s_add_u32 s80, s101, 204800
    buffer_load_dwordx4 v[76:79], v7, s[8:11], s80 offen offset:0 sc1
    buffer_load_dwordx4 v[80:83], v7, s[8:11], s80 offen offset:1024 sc1
    buffer_load_dwordx4 v[84:87], v7, s[8:11], s80 offen offset:2048 sc1
    buffer_load_dwordx4 v[88:91], v7, s[8:11], s80 offen offset:3072 sc1
    buffer_load_dwordx4 v[92:95], v1, s[8:11], s80 offen sc1
    s_add_u32 s80, s101, 225280
    buffer_load_dwordx4 v[96:99], v7, s[8:11], s80 offen offset:0 sc1
    buffer_load_dwordx4 v[100:103], v7, s[8:11], s80 offen offset:1024 sc1
    buffer_load_dwordx4 v[104:107], v7, s[8:11], s80 offen offset:2048 sc1
    buffer_load_dwordx4 v[108:111], v7, s[8:11], s80 offen offset:3072 sc1
    buffer_load_dwordx4 v[112:115], v1, s[8:11], s80 offen sc1
    v_min_u32 v15, 95, v14
    v_lshlrev_b32 v15, 3, v15
    s_cmp_eq_u32 s39, 0
    s_cbranch_scc1 K_hjoin
    s_mul_i32 s80, s40, 12288
    s_add_u32 s80, s80, 17301504
    s_add_u32 s68, s34, s80
    s_addc_u32 s69, s35, 0
    s_mov_b32 s70, 12288
    s_mov_b32 s71, 0x20000
    s_sub_u32 s80, 15, s36
    s_mul_i32 s80, s80, 768
    v_lshl_add_u32 v16, v14, 3, s80
    v_cmp_gt_u32 vcc, 96, v14
    v_mov_b32 v32, 0x7fff0000
    s_nop 1
    v_cndmask_b32 v16, v32, v16, vcc
    v_add_u32 v15, 148480, v15
    s_movk_i32 s84, 3840
    s_movk_i32 s85, 7680
    s_setprio 3
    s_barrier
    ds_read_b64 v[176:177], v15 offset:0
    ds_read_b64 v[178:179], v15 offset:768
    ds_read_b64 v[180:181], v15 offset:1536
    ds_read_b64 v[182:183], v15 offset:2304
    ds_read_b64 v[184:185], v15 offset:3072
    ds_read_b64 v[186:187], v15 offset:3840
    ds_read_b64 v[188:189], v15 offset:4608
    ds_read_b64 v[190:191], v15 offset:5376
    s_waitcnt lgkmcnt(6)
    v_pk_fma_f32 v[194:195], v[28:29], v[176:177], v[178:179] op_sel:[0,0,0] op_sel_hi:[0,1,1]
    v_pk_fma_f32 v[194:195], v[28:29], v[176:177], v[194:195] op_sel:[1,1,0] op_sel_hi:[1,0,1] neg_lo:[1,0,0]
    s_waitcnt lgkmcnt(5)
    v_pk_fma_f32 v[192:193], v[28:29], v[194:195], v[180:181] op_sel:[0,0,0] op_sel_hi:[0,1,1]
    v_pk_fma_f32 v[192:193], v[28:29], v[194:195], v[192:193] op_sel:[1,1,0] op_sel_hi:[1,0,1] neg_lo:[1,0,0]
    s_waitcnt lgkmcnt(4)
    v_pk_fma_f32 v[194:195], v[28:29], v[192:193], v[182:183] op_sel:[0,0,0] op_sel_hi:[0,1,1]
    v_pk_fma_f32 v[194:195], v[28:29], v[192:193], v[194:195] op_sel:[1,1,0] op_sel_hi:[1,0,1] neg_lo:[1,0,0]
    s_waitcnt lgkmcnt(3)
    v_pk_fma_f32 v[192:193], v[28:29], v[194:195], v[184:185] op_sel:[0,0,0] op_sel_hi:[0,1,1]
    v_pk_fma_f32 v[192:193], v[28:29], v[194:195], v[192:193] op_sel:[1,1,0] op_sel_hi:[1,0,1] neg_lo:[1,0,0]
    s_waitcnt lgkmcnt(2)
    v_pk_fma_f32 v[194:195], v[28:29], v[192:193], v[186:187] op_sel:[0,0,0] op_sel_hi:[0,1,1]
    v_pk_fma_f32 v[194:195], v[28:29], v[192:193], v[194:195] op_sel:[1,1,0] op_sel_hi:[1,0,1] neg_lo:[1,0,0]
    s_waitcnt lgkmcnt(1)
    v_pk_fma_f32 v[192:193], v[28:29], v[194:195], v[188:189] op_sel:[0,0,0] op_sel_hi:[0,1,1]
    v_pk_fma_f32 v[192:193], v[28:29], v[194:195], v[192:193] op_sel:[1,1,0] op_sel_hi:[1,0,1] neg_lo:[1,0,0]
    s_waitcnt lgkmcnt(0)
    v_pk_fma_f32 v[194:195], v[28:29], v[192:193], v[190:191] op_sel:[0,0,0] op_sel_hi:[0,1,1]
    v_pk_fma_f32 v[194:195], v[28:29], v[192:193], v[194:195] op_sel:[1,1,0] op_sel_hi:[1,0,1] neg_lo:[1,0,0]
    v_min_u32 v32, -2, v194
    v_min_u32 v33, -2, v195
    buffer_store_dwordx2 v[32:33], v16, s[68:71], 0 offen sc1
    v_pk_fma_f32 v[192:193], v[22:23], v[176:177], 0 op_sel:[0,0,0] op_sel_hi:[0,1,1]
    v_pk_fma_f32 v[192:193], v[22:23], v[176:177], v[192:193] op_sel:[1,1,0] op_sel_hi:[1,0,1] neg_lo:[1,0,0]
    v_mov_b32 v176, v192
    v_mov_b32 v177, v193
    v_pk_fma_f32 v[192:193], v[22:23], v[178:179], 0 op_sel:[0,0,0] op_sel_hi:[0,1,1]
    v_pk_fma_f32 v[192:193], v[22:23], v[178:179], v[192:193] op_sel:[1,1,0] op_sel_hi:[1,0,1] neg_lo:[1,0,0]
    v_mov_b32 v178, v192
    v_mov_b32 v179, v193
    v_pk_fma_f32 v[192:193], v[22:23], v[180:181], 0 op_sel:[0,0,0] op_sel_hi:[0,1,1]
    v_pk_fma_f32 v[192:193], v[22:23], v[180:181], v[192:193] op_sel:[1,1,0] op_sel_hi:[1,0,1] neg_lo:[1,0,0]
    v_mov_b32 v180, v192
    v_mov_b32 v181, v193
    v_pk_fma_f32 v[192:193], v[22:23], v[182:183], 0 op_sel:[0,0,0] op_sel_hi:[0,1,1]
    v_pk_fma_f32 v[192:193], v[22:23], v[182:183], v[192:193] op_sel:[1,1,0] op_sel_hi:[1,0,1] neg_lo:[1,0,0]
    v_mov_b32 v182, v192
    v_mov_b32 v183, v193
    v_pk_fma_f32 v[192:193], v[22:23], v[184:185], 0 op_sel:[0,0,0] op_sel_hi:[0,1,1]
    v_pk_fma_f32 v[192:193], v[22:23], v[184:185], v[192:193] op_sel:[1,1,0] op_sel_hi:[1,0,1] neg_lo:[1,0,0]
    v_mov_b32 v184, v192
    v_mov_b32 v185, v193
    v_pk_fma_f32 v[192:193], v[22:23], v[186:187], 0 op_sel:[0,0,0] op_sel_hi:[0,1,1]
    v_pk_fma_f32 v[192:193], v[22:23], v[186:187], v[192:193] op_sel:[1,1,0] op_sel_hi:[1,0,1] neg_lo:[1,0,0]
    v_mov_b32 v186, v192
    v_mov_b32 v187, v193
    v_pk_fma_f32 v[192:193], v[22:23], v[188:189], 0 op_sel:[0,0,0] op_sel_hi:[0,1,1]
    v_pk_fma_f32 v[192:193], v[22:23], v[188:189], v[192:193] op_sel:[1,1,0] op_sel_hi:[1,0,1] neg_lo:[1,0,0]
    v_mov_b32 v188, v192
    v_mov_b32 v189, v193
    s_waitcnt vmcnt(0)
    buffer_load_dwordx2 v[226:227], v16, s[68:71], 0 offen offset:768 sc1
    buffer_load_dwordx2 v[228:229], v16, s[68:71], 0 offen offset:1536 sc1
    buffer_load_dwordx2 v[230:231], v16, s[68:71], 0 offen offset:2304 sc1
    buffer_load_dwordx2 v[232:233], v16, s[68:71], 0 offen offset:3072 sc1
    buffer_load_dwordx2 v[234:235], v16, s[68:71], 0 offen offset:3840 sc1
    buffer_load_dwordx2 v[236:237], v16, s[68:71], s84 offen offset:768 sc1
    buffer_load_dwordx2 v[238:239], v16, s[68:71], s84 offen offset:1536 sc1
    buffer_load_dwordx2 v[240:241], v16, s[68:71], s84 offen offset:2304 sc1
    buffer_load_dwordx2 v[242:243], v16, s[68:71], s84 offen offset:3072 sc1
    buffer_load_dwordx2 v[244:245], v16, s[68:71], s84 offen offset:3840 sc1
    buffer_load_dwordx2 v[246:247], v16, s[68:71], s85 offen offset:768 sc1
    buffer_load_dwordx2 v[248:249], v16, s[68:71], s85 offen offset:1536 sc1
    buffer_load_dwordx2 v[250:251], v16, s[68:71], s85 offen offset:2304 sc1
    buffer_load_dwordx2 v[252:253], v16, s[68:71], s85 offen offset:3072 sc1
    buffer_load_dwordx2 v[254:255], v16, s[68:71], s85 offen offset:3840 sc1
    s_mov_b32 s80, 131072
K_lb_61:
    s_waitcnt vmcnt(0)
    v_max_u32 v34, v226, v227
    v_max3_u32 v34, v228, v229, v34
    v_max3_u32 v34, v230, v231, v34
    v_max3_u32 v34, v232, v233, v34
    v_max3_u32 v34, v234, v235, v34
    v_max3_u32 v34, v236, v237, v34
    v_max3_u32 v34, v238, v239, v34
    v_max3_u32 v34, v240, v241, v34
    v_max3_u32 v34, v242, v243, v34
    v_max3_u32 v34, v244, v245, v34
    v_max3_u32 v34, v246, v247, v34
    v_max3_u32 v34, v248, v249, v34
    v_max3_u32 v34, v250, v251, v34
    v_max3_u32 v34, v252, v253, v34
    v_max3_u32 v34, v254, v255, v34
    v_cmp_eq_u32 vcc, -1, v34
    s_cbranch_vccz K_lbok_62
    s_sub_u32 s80, s80, 1
    s_cmp_eq_u32 s80, 0
    s_cbranch_scc1 K_lbok_62
    buffer_load_dwordx2 v[226:227], v16, s[68:71], 0 offen offset:768 sc1
    buffer_load_dwordx2 v[228:229], v16, s[68:71], 0 offen offset:1536 sc1
    buffer_load_dwordx2 v[230:231], v16, s[68:71], 0 offen offset:2304 sc1
    buffer_load_dwordx2 v[232:233], v16, s[68:71], 0 offen offset:3072 sc1
    buffer_load_dwordx2 v[234:235], v16, s[68:71], 0 offen offset:3840 sc1
    buffer_load_dwordx2 v[236:237], v16, s[68:71], s84 offen offset:768 sc1
    buffer_load_dwordx2 v[238:239], v16, s[68:71], s84 offen offset:1536 sc1
    buffer_load_dwordx2 v[240:241], v16, s[68:71], s84 offen offset:2304 sc1
    buffer_load_dwordx2 v[242:243], v16, s[68:71], s84 offen offset:3072 sc1
    buffer_load_dwordx2 v[244:245], v16, s[68:71], s84 offen offset:3840 sc1
    buffer_load_dwordx2 v[246:247], v16, s[68:71], s85 offen offset:768 sc1
    buffer_load_dwordx2 v[248:249], v16, s[68:71], s85 offen offset:1536 sc1
    buffer_load_dwordx2 v[250:251], v16, s[68:71], s85 offen offset:2304 sc1
    buffer_load_dwordx2 v[252:253], v16, s[68:71], s85 offen offset:3072 sc1
    buffer_load_dwordx2 v[254:255], v16, s[68:71], s85 offen offset:3840 sc1
    s_branch K_lb_61
K_lbok_62:
    v_pk_fma_f32 v[192:193], v[26:27], v[254:255], v[252:253] op_sel:[0,0,0] op_sel_hi:[0,1,1]
    v_pk_fma_f32 v[192:193], v[26:27], v[254:255], v[192:193] op_sel:[1,1,0] op_sel_hi:[1,0,1] neg_lo:[1,0,0]
    v_pk_fma_f32 v[194:195], v[26:27], v[192:193], v[250:251] op_sel:[0,0,0] op_sel_hi:[0,1,1]
    v_pk_fma_f32 v[194:195], v[26:27], v[192:193], v[194:195] op_sel:[1,1,0] op_sel_hi:[1,0,1] neg_lo:[1,0,0]
    v_pk_fma_f32 v[192:193], v[26:27], v[194:195], v[248:249] op_sel:[0,0,0] op_sel_hi:[0,1,1]
    v_pk_fma_f32 v[192:193], v[26:27], v[194:195], v[192:193] op_sel:[1,1,0] op_sel_hi:[1,0,1] neg_lo:[1,0,0]
    v_pk_fma_f32 v[194:195], v[26:27], v[192:193], v[246:247] op_sel:[0,0,0] op_sel_hi:[0,1,1]
    v_pk_fma_f32 v[194:195], v[26:27], v[192:193], v[194:195] op_sel:[1,1,0] op_sel_hi:[1,0,1] neg_lo:[1,0,0]
    v_pk_fma_f32 v[192:193], v[26:27], v[194:195], v[244:245] op_sel:[0,0,0] op_sel_hi:[0,1,1]
    v_pk_fma_f32 v[192:193], v[26:27], v[194:195], v[192:193] op_sel:[1,1,0] op_sel_hi:[1,0,1] neg_lo:[1,0,0]
    v_pk_fma_f32 v[194:195], v[26:27], v[192:193], v[242:243] op_sel:[0,0,0] op_sel_hi:[0,1,1]
    v_pk_fma_f32 v[194:195], v[26:27], v[192:193], v[194:195] op_sel:[1,1,0] op_sel_hi:[1,0,1] neg_lo:[1,0,0]
    v_pk_fma_f32 v[192:193], v[26:27], v[194:195], v[240:241] op_sel:[0,0,0] op_sel_hi:[0,1,1]
    v_pk_fma_f32 v[192:193], v[26:27], v[194:195], v[192:193] op_sel:[1,1,0] op_sel_hi:[1,0,1] neg_lo:[1,0,0]
    v_pk_fma_f32 v[194:195], v[26:27], v[192:193], v[238:239] op_sel:[0,0,0] op_sel_hi:[0,1,1]
    v_pk_fma_f32 v[194:195], v[26:27], v[192:193], v[194:195] op_sel:[1,1,0] op_sel_hi:[1,0,1] neg_lo:[1,0,0]
    v_pk_fma_f32 v[192:193], v[26:27], v[194:195], v[236:237] op_sel:[0,0,0] op_sel_hi:[0,1,1]
    v_pk_fma_f32 v[192:193], v[26:27], v[194:195], v[192:193] op_sel:[1,1,0] op_sel_hi:[1,0,1] neg_lo:[1,0,0]
    v_pk_fma_f32 v[194:195], v[26:27], v[192:193], v[234:235] op_sel:[0,0,0] op_sel_hi:[0,1,1]
    v_pk_fma_f32 v[194:195], v[26:27], v[192:193], v[194:195] op_sel:[1,1,0] op_sel_hi:[1,0,1] neg_lo:[1,0,0]
    v_pk_fma_f32 v[192:193], v[26:27], v[194:195], v[232:233] op_sel:[0,0,0] op_sel_hi:[0,1,1]
    v_pk_fma_f32 v[192:193], v[26:27], v[194:195], v[192:193] op_sel:[1,1,0] op_sel_hi:[1,0,1] neg_lo:[1,0,0]
    v_pk_fma_f32 v[194:195], v[26:27], v[192:193], v[230:231] op_sel:[0,0,0] op_sel_hi:[0,1,1]
    v_pk_fma_f32 v[194:195], v[26:27], v[192:193], v[194:195] op_sel:[1,1,0] op_sel_hi:[1,0,1] neg_lo:[1,0,0]
    v_pk_fma_f32 v[192:193], v[26:27], v[194:195], v[228:229] op_sel:[0,0,0] op_sel_hi:[0,1,1]
    v_pk_fma_f32 v[192:193], v[26:27], v[194:195], v[192:193] op_sel:[1,1,0] op_sel_hi:[1,0,1] neg_lo:[1,0,0]
    v_pk_fma_f32 v[194:195], v[26:27], v[192:193], v[226:227] op_sel:[0,0,0] op_sel_hi:[0,1,1]
    v_pk_fma_f32 v[194:195], v[26:27], v[192:193], v[194:195] op_sel:[1,1,0] op_sel_hi:[1,0,1] neg_lo:[1,0,0]
    v_pk_fma_f32 v[226:227], v[22:23], v[194:195], 0 op_sel:[0,0,0] op_sel_hi:[0,1,1]
    v_pk_fma_f32 v[226:227], v[22:23], v[194:195], v[226:227] op_sel:[1,1,0] op_sel_hi:[1,0,1] neg_lo:[1,0,0]
    v_cmp_gt_u32 vcc, 96, v14
    s_and_saveexec_b64 s[88:89], vcc
    ds_write_b64 v15, v[226:227] offset:6144
    v_pk_fma_f32 v[228:229], v[28:29], v[226:227], v[176:177] op_sel:[0,0,0] op_sel_hi:[0,1,1]
    v_pk_fma_f32 v[228:229], v[28:29], v[226:227], v[228:229] op_sel:[1,1,0] op_sel_hi:[1,0,1] neg_lo:[1,0,0]
    ds_write_b64 v15, v[228:229] offset:6912
    v_pk_fma_f32 v[230:231], v[28:29], v[228:229], v[178:179] op_sel:[0,0,0] op_sel_hi:[0,1,1]
    v_pk_fma_f32 v[230:231], v[28:29], v[228:229], v[230:231] op_sel:[1,1,0] op_sel_hi:[1,0,1] neg_lo:[1,0,0]
    ds_write_b64 v15, v[230:231] offset:7680
    v_pk_fma_f32 v[232:233], v[28:29], v[230:231], v[180:181] op_sel:[0,0,0] op_sel_hi:[0,1,1]
    v_pk_fma_f32 v[232:233], v[28:29], v[230:231], v[232:233] op_sel:[1,1,0] op_sel_hi:[1,0,1] neg_lo:[1,0,0]
    ds_write_b64 v15, v[232:233] offset:8448
    v_pk_fma_f32 v[234:235], v[28:29], v[232:233], v[182:183] op_sel:[0,0,0] op_sel_hi:[0,1,1]
    v_pk_fma_f32 v[234:235], v[28:29], v[232:233], v[234:235] op_sel:[1,1,0] op_sel_hi:[1,0,1] neg_lo:[1,0,0]
    ds_write_b64 v15, v[234:235] offset:9216
    v_pk_fma_f32 v[236:237], v[28:29], v[234:235], v[184:185] op_sel:[0,0,0] op_sel_hi:[0,1,1]
    v_pk_fma_f32 v[236:237], v[28:29], v[234:235], v[236:237] op_sel:[1,1,0] op_sel_hi:[1,0,1] neg_lo:[1,0,0]
    ds_write_b64 v15, v[236:237] offset:9984
    v_pk_fma_f32 v[238:239], v[28:29], v[236:237], v[186:187] op_sel:[0,0,0] op_sel_hi:[0,1,1]
    v_pk_fma_f32 v[238:239], v[28:29], v[236:237], v[238:239] op_sel:[1,1,0] op_sel_hi:[1,0,1] neg_lo:[1,0,0]
    ds_write_b64 v15, v[238:239] offset:10752
    v_pk_fma_f32 v[240:241], v[28:29], v[238:239], v[188:189] op_sel:[0,0,0] op_sel_hi:[0,1,1]
    v_pk_fma_f32 v[240:241], v[28:29], v[238:239], v[240:241] op_sel:[1,1,0] op_sel_hi:[1,0,1] neg_lo:[1,0,0]
    ds_write_b64 v15, v[240:241] offset:11520
    s_mov_b64 exec, s[88:89]
    s_waitcnt lgkmcnt(0)
K_b12_60:
    s_barrier
K_hjoin:
    s_setprio 0
    v_add_u32 v8, s17, v7
    v_add_u32 v9, 0x10000, v8
    s_mov_b32 s81, 0xffff0000
    s_mul_i32 s82, s38, 10240
    s_add_u32 s82, s82, 102400
    s_add_u32 s78, s96, 1
    s_cmp_eq_u32 s38, 2
    s_cselect_b32 s78, s78, 0
    s_lshl_b32 s77, s36, 12
    s_add_u32 s77, s77, 17563648
    v_bfe_u32 v21, v2, 3, 1
    v_lshl_add_u32 v21, v21, 11, s77
    v_and_b32 v22, 3, v2
    v_min_u32 v22, 2, v22
    v_lshl_add_u32 v20, v22, 7, v21
    v_add_u32 v20, 768, v20
    v_add_u32 v23, 0x10000, v20
    v_cmp_gt_u32 vcc, 2, v22
    v_and_b32 v22, 7, v2
    v_min_u32 v22, 5, v22
    v_cndmask_b32 v20, v20, v23, vcc
    v_lshlrev_b32 v22, 7, v22
    v_add_u32 v22, 1024, v22
    v_and_b32 v23, 1, v2
    v_lshlrev_b32 v23, 7, v23
    v_add_u32 v23, 67328, v23
    s_cmp_eq_u32 s96, 1
    s_cselect_b64 vcc, -1, 0
    v_cndmask_b32 v22, v23, v22, vcc
    v_add_u32 v21, v21, v22
    s_setprio 3
    s_cmp_lg_u32 s78, 2
    s_cbranch_scc1 K_gpok_65
    s_mov_b32 s80, 131072
K_gp_64:
    buffer_load_dwordx2 v[22:23], v20, s[56:59], 0 offen sc1
K_gp_64c:
    s_waitcnt vmcnt(0)
    v_and_b32 v22, v22, v23
    v_cmp_ne_u32 vcc, 1, v22
    s_cbranch_vccz K_gpok_65x
    s_sleep 2
    s_sub_u32 s80, s80, 1
    s_cmp_lg_u32 s80, 0
    s_cbranch_scc1 K_gp_64
K_gpok_65x:
    v_mov_b32 v24, 160772
    v_mov_b32 v22, 1
    ds_write_b32 v24, v22
K_gpok_65:
    s_setprio 0
    s_waitcnt vmcnt(30) lgkmcnt(0)
    s_barrier
    s_mov_b32 s64, s20
    s_mov_b32 s65, s21
    s_mov_b32 s66, 1280
    s_mov_b32 s67, 0x20000
    s_mov_b32 s44, s22
    s_mov_b32 s45, s23
    s_mov_b32 s46, 2621440
    s_mov_b32 s47, 0x20000
    s_lshl_b32 s76, s38, 2
    s_add_u32 s76, s76, s19
    v_mov_b32 v10, 0
    s_lshl_b32 s85, s36, 7
    s_lshl_b32 s92, s38, 5
    s_add_u32 s85, s85, s92
    s_mul_i32 s85, s85, 2560
    s_mul_i32 s93, s97, 320
    s_add_u32 s85, s85, s93
    s_add_u32 s83, s85, 40960
    s_lshr_b32 s93, s93, 1
    s_lshr_b32 s84, s85, 1
    s_lshr_b32 s79, s83, 1
    s_lshl_b32 s92, s92, 3
    s_add_u32 s92, s92, 147456
    s_sub_u32 s98, s82, s17
    s_sub_u32 s98, s98, 81920
    s_add_u32 s74, s18, 4096
    s_waitcnt lgkmcnt(0)
    s_barrier
    s_cmp_ge_u32 s38, 2
    s_cbranch_scc1 K_nwr_66
    s_waitcnt vmcnt(0)
    ds_write_b128 v8, v[116:119] offset:40960
    ds_write_b128 v8, v[120:123] offset:41984
    ds_write_b128 v8, v[124:127] offset:43008
    ds_write_b128 v8, v[128:131] offset:44032
    ds_write_b128 v8, v[132:135] offset:45056
    ds_write_b128 v8, v[136:139] offset:51200
    ds_write_b128 v8, v[140:143] offset:52224
    ds_write_b128 v8, v[144:147] offset:53248
    ds_write_b128 v8, v[148:151] offset:54272
    ds_write_b128 v8, v[152:155] offset:55296
K_nwr_66:
    s_cmp_ge_u32 s38, 2
    s_cbranch_scc1 K_dg_67
    s_add_u32 s80, s17, 163840
    buffer_load_dwordx4 v[36:39], v7, s[8:11], s80 offen offset:0 sc1
    buffer_load_dwordx4 v[40:43], v7, s[8:11], s80 offen offset:1024 sc1
    buffer_load_dwordx4 v[44:47], v7, s[8:11], s80 offen offset:2048 sc1
    buffer_load_dwordx4 v[48:51], v7, s[8:11], s80 offen offset:3072 sc1
    buffer_load_dwordx4 v[52:55], v1, s[8:11], s80 offen sc1
K_dg_67:
    s_setprio 3
    s_cmp_lg_u32 s78, 2
    s_cbranch_scc1 K_gpok_69
    s_mov_b32 s80, 131072
K_gp_68:
    buffer_load_dwordx2 v[22:23], v21, s[56:59], 0 offen sc1
K_gp_68c:
    s_waitcnt vmcnt(0)
    v_and_b32 v22, v22, v23
    v_cmp_ne_u32 vcc, 1, v22
    s_cbranch_vccz K_gpok_69x
    s_sleep 2
    s_sub_u32 s80, s80, 1
    s_cmp_lg_u32 s80, 0
    s_cbranch_scc1 K_gp_68
K_gpok_69x:
K_gpok_69:
    s_setprio 0
    s_waitcnt lgkmcnt(0)
    s_barrier
    s_cmp_ge_u32 s38, 2
    s_cbranch_scc1 K_nwr_70
    ds_write_b128 v8, v[156:159] offset:61440
    ds_write_b128 v8, v[160:163] offset:62464
    ds_write_b128 v8, v[164:167] offset:63488
    ds_write_b128 v8, v[168:171] offset:64512
    ds_write_b128 v9, v[172:175] offset:0
    ds_write_b128 v9, v[176:179] offset:6144
    ds_write_b128 v9, v[180:183] offset:7168
    ds_write_b128 v9, v[184:187] offset:8192
    ds_write_b128 v9, v[188:191] offset:9216
    ds_write_b128 v9, v[192:195] offset:10240
K_nwr_70:
    s_cmp_ge_u32 s38, 2
    s_cbranch_scc1 K_dg_71
    s_add_u32 s80, s101, 184320
    buffer_load_dwordx4 v[56:59], v7, s[8:11], s80 offen offset:0 sc1
    buffer_load_dwordx4 v[60:63], v7, s[8:11], s80 offen offset:1024 sc1
    buffer_load_dwordx4 v[64:67], v7, s[8:11], s80 offen offset:2048 sc1
    buffer_load_dwordx4 v[68:71], v7, s[8:11], s80 offen offset:3072 sc1
    buffer_load_dwordx4 v[72:75], v1, s[8:11], s80 offen sc1
K_dg_71:
    s_waitcnt lgkmcnt(0)
    s_barrier
    s_cmp_ge_u32 s38, 2
    s_cbranch_scc1 K_nwr_72
    ds_write_b128 v9, v[196:199] offset:16384
    ds_write_b128 v9, v[200:203] offset:17408
    ds_write_b128 v9, v[204:207] offset:18432
    ds_write_b128 v9, v[208:211] offset:19456
    ds_write_b128 v9, v[212:215] offset:20480
    ds_write_b128 v9, v[216:219] offset:26624
    ds_write_b128 v9, v[220:223] offset:27648
    ds_write_b128 v9, v[224:227] offset:28672
    ds_write_b128 v9, v[228:231] offset:29696
    ds_write_b128 v9, v[232:235] offset:30720
K_nwr_72:
    s_cmp_ge_u32 s38, 2
    s_cbranch_scc1 K_dg_73
    s_add_u32 s80, s101, 204800
    buffer_load_dwordx4 v[76:79], v7, s[8:11], s80 offen offset:0 sc1
    buffer_load_dwordx4 v[80:83], v7, s[8:11], s80 offen offset:1024 sc1
    buffer_load_dwordx4 v[84:87], v7, s[8:11], s80 offen offset:2048 sc1
    buffer_load_dwordx4 v[88:91], v7, s[8:11], s80 offen offset:3072 sc1
    buffer_load_dwordx4 v[92:95], v1, s[8:11], s80 offen sc1
K_dg_73:
    s_waitcnt lgkmcnt(0)
    s_barrier
    s_waitcnt vmcnt(10)
    ds_write_b128 v8, v[36:39] offset:0
    ds_write_b128 v8, v[40:43] offset:1024
    ds_write_b128 v8, v[44:47] offset:2048
    ds_write_b128 v8, v[48:51] offset:3072
    ds_write_b128 v8, v[52:55] offset:4096
    s_cmp_ge_u32 s38, 2
    s_cbranch_scc1 K_dg_74
    s_add_u32 s80, s101, 225280
    buffer_load_dwordx4 v[96:99], v7, s[8:11], s80 offen offset:0 sc1
    buffer_load_dwordx4 v[100:103], v7, s[8:11], s80 offen offset:1024 sc1
    buffer_load_dwordx4 v[104:107], v7, s[8:11], s80 offen offset:2048 sc1
    buffer_load_dwordx4 v[108:111], v7, s[8:11], s80 offen offset:3072 sc1
    buffer_load_dwordx4 v[112:115], v1, s[8:11], s80 offen sc1
K_dg_74:
    s_cmp_lg_u32 s78, 1
    s_cbranch_scc1 K_gpok_76
    buffer_load_dwordx2 v[22:23], v21, s[56:59], 0 offen sc1
K_gpok_76:
    s_waitcnt lgkmcnt(0)
    s_barrier
    s_waitcnt vmcnt(10)
    ds_write_b128 v8, v[56:59] offset:20480
    ds_write_b128 v8, v[60:63] offset:21504
    ds_write_b128 v8, v[64:67] offset:22528
    ds_write_b128 v8, v[68:71] offset:23552
    ds_write_b128 v8, v[72:75] offset:24576
    s_waitcnt lgkmcnt(0)
    s_barrier
    s_waitcnt vmcnt(5)
    ds_write_b128 v8, v[76:79] offset:40960
    ds_write_b128 v8, v[80:83] offset:41984
    ds_write_b128 v8, v[84:87] offset:43008
    ds_write_b128 v8, v[88:91] offset:44032
    ds_write_b128 v8, v[92:95] offset:45056
    s_cmp_lg_u32 s78, 1
    s_cbranch_scc1 K_gpok_78
    s_mov_b32 s80, 131072
    s_branch K_gp_77c
K_gp_77:
    buffer_load_dwordx2 v[22:23], v21, s[56:59], 0 offen sc1
K_gp_77c:
    s_waitcnt vmcnt(0)
    v_and_b32 v22, v22, v23
    v_cmp_ne_u32 vcc, 1, v22
    s_cbranch_vccz K_gpok_78x
    s_sleep 2
    s_sub_u32 s80, s80, 1
    s_cmp_lg_u32 s80, 0
    s_cbranch_scc1 K_gp_77
K_gpok_78x:
K_gpok_78:
    s_waitcnt lgkmcnt(0)
    s_barrier
    s_waitcnt vmcnt(0)
    ds_write_b128 v8, v[96:99] offset:61440
    ds_write_b128 v8, v[100:103] offset:62464
    ds_write_b128 v8, v[104:107] offset:63488
    ds_write_b128 v8, v[108:111] offset:64512
    ds_write_b128 v9, v[112:115] offset:0
    s_cmp_eq_u32 s96, 0
    s_cbranch_scc1 K_bl_79
    v_add_u32 v33, 0, v2
    v_mul_u32_u24 v32, 3277, v33
    v_lshrrev_b32 v32, 16, v32
    v_mad_i32_i24 v33, v32, -16, v33
    v_mad_i32_i24 v33, v32, -4, v33
    v_xor_b32 v12, v32, v33
    v_and_b32 v12, 15, v12
    v_lshlrev_b32 v12, 4, v12
    v_lshl_add_u32 v12, v33, 8, v12
    v_add_u32 v12, s82, v12
    v_mul_u32_u24 v34, 2560, v32
    v_lshl_add_u32 v195, v33, 4, v34
    v_subrev_u32 v190, s98, v12
    v_lshrrev_b32 v34, 1, v195
    v_lshlrev_b32 v33, 3, v33
    v_lshl_add_u32 v32, v32, 3, s92
    buffer_load_dwordx2 v[140:141], v34, s[44:47], s84 offen
    buffer_load_dwordx2 v[142:143], v34, s[44:47], s79 offen
    buffer_load_dwordx2 v[160:161], v33, s[64:67], s93 offen
    ds_read_b64 v[170:171], v32
    ds_read_b64 v[172:173], v32 offset:128
    v_add_u32 v33, 64, v2
    v_mul_u32_u24 v32, 3277, v33
    v_lshrrev_b32 v32, 16, v32
    v_mad_i32_i24 v33, v32, -16, v33
    v_mad_i32_i24 v33, v32, -4, v33
    v_xor_b32 v13, v32, v33
    v_and_b32 v13, 15, v13
    v_lshlrev_b32 v13, 4, v13
    v_lshl_add_u32 v13, v33, 8, v13
    v_add_u32 v13, s82, v13
    v_mul_u32_u24 v34, 2560, v32
    v_lshl_add_u32 v196, v33, 4, v34
    v_subrev_u32 v191, s98, v13
    v_lshrrev_b32 v34, 1, v196
    v_lshlrev_b32 v33, 3, v33
    v_lshl_add_u32 v32, v32, 3, s92
    buffer_load_dwordx2 v[144:145], v34, s[44:47], s84 offen
    buffer_load_dwordx2 v[146:147], v34, s[44:47], s79 offen
    buffer_load_dwordx2 v[162:163], v33, s[64:67], s93 offen
    ds_read_b64 v[174:175], v32
    ds_read_b64 v[176:177], v32 offset:128
K_bl_79:
    s_waitcnt lgkmcnt(0)
    s_barrier
    s_cmp_eq_u32 s96, 0
    s_cbranch_scc1 K_bl_80
    v_add_u32 v33, 128, v2
    v_mul_u32_u24 v32, 3277, v33
    v_lshrrev_b32 v32, 16, v32
    v_mad_i32_i24 v33, v32, -16, v33
    v_mad_i32_i24 v33, v32, -4, v33
    v_xor_b32 v14, v32, v33
    v_and_b32 v14, 15, v14
    v_lshlrev_b32 v14, 4, v14
    v_lshl_add_u32 v14, v33, 8, v14
    v_add_u32 v14, s82, v14
    v_mul_u32_u24 v34, 2560, v32
    v_lshl_add_u32 v197, v33, 4, v34
    v_subrev_u32 v192, s98, v14
    v_lshrrev_b32 v34, 1, v197
    v_lshlrev_b32 v33, 3, v33
    v_lshl_add_u32 v32, v32, 3, s92
    buffer_load_dwordx2 v[148:149], v34, s[44:47], s84 offen
    buffer_load_dwordx2 v[150:151], v34, s[44:47], s79 offen
    buffer_load_dwordx2 v[164:165], v33, s[64:67], s93 offen
    ds_read_b64 v[178:179], v32
    ds_read_b64 v[180:181], v32 offset:128
    v_add_u32 v33, 192, v2
    v_mul_u32_u24 v32, 3277, v33
    v_lshrrev_b32 v32, 16, v32
    v_mad_i32_i24 v33, v32, -16, v33
    v_mad_i32_i24 v33, v32, -4, v33
    v_xor_b32 v15, v32, v33
    v_and_b32 v15, 15, v15
    v_lshlrev_b32 v15, 4, v15
    v_lshl_add_u32 v15, v33, 8, v15
    v_add_u32 v15, s82, v15
    v_mul_u32_u24 v34, 2560, v32
    v_lshl_add_u32 v198, v33, 4, v34
    v_subrev_u32 v193, s98, v15
    v_lshrrev_b32 v34, 1, v198
    v_lshlrev_b32 v33, 3, v33
    v_lshl_add_u32 v32, v32, 3, s92
    buffer_load_dwordx2 v[152:153], v34, s[44:47], s84 offen
    buffer_load_dwordx2 v[154:155], v34, s[44:47], s79 offen
    buffer_load_dwordx2 v[166:167], v33, s[64:67], s93 offen
    ds_read_b64 v[182:183], v32
    ds_read_b64 v[184:185], v32 offset:128
    v_add_u32 v33, 256, v2
    v_mul_u32_u24 v32, 3277, v33
    v_lshrrev_b32 v32, 16, v32
    v_mad_i32_i24 v33, v32, -16, v33
    v_mad_i32_i24 v33, v32, -4, v33
    v_xor_b32 v16, v32, v33
    v_and_b32 v16, 15, v16
    v_lshlrev_b32 v16, 4, v16
    v_lshl_add_u32 v16, v33, 8, v16
    v_add_u32 v16, s82, v16
    v_mul_u32_u24 v34, 2560, v32
    v_lshl_add_u32 v199, v33, 4, v34
    v_subrev_u32 v194, s98, v16
    v_lshrrev_b32 v34, 1, v199
    v_lshlrev_b32 v33, 3, v33
    v_lshl_add_u32 v32, v32, 3, s92
    buffer_load_dwordx2 v[156:157], v34, s[44:47], s84 offen
    buffer_load_dwordx2 v[158:159], v34, s[44:47], s79 offen
    buffer_load_dwordx2 v[168:169], v33, s[64:67], s93 offen
    ds_read_b64 v[186:187], v32
    ds_read_b64 v[188:189], v32 offset:128
K_bl_80:
K_hend:
    s_cmp_eq_u32 s96, 0
    s_cbranch_scc1 K_fin
    s_mov_b32 s80, 131072
    s_waitcnt lgkmcnt(0)
    s_waitcnt vmcnt(12)
    v_lshlrev_b32 v28, 16, v160
    v_and_b32 v29, s81, v160
    v_lshlrev_b32 v30, 16, v161
    v_and_b32 v31, s81, v161
    v_lshlrev_b32 v100, 16, v140
    v_and_b32 v101, s81, v140
    v_lshlrev_b32 v102, 16, v141
    v_and_b32 v103, s81, v141
    v_sub_f32 v32, v100, v170
    v_sub_f32 v33, v101, v170
    v_sub_f32 v34, v102, v170
    v_sub_f32 v35, v103, v170
    v_mul_f32 v32, v32, v171
    v_mul_f32 v33, v33, v171
    v_mul_f32 v34, v34, v171
    v_mul_f32 v35, v35, v171
    v_fmac_f32 v100, v32, v28
    v_fmac_f32 v101, v33, v29
    v_fmac_f32 v102, v34, v30
    v_fmac_f32 v103, v35, v31
    v_lshlrev_b32 v104, 16, v142
    v_and_b32 v105, s81, v142
    v_lshlrev_b32 v106, 16, v143
    v_and_b32 v107, s81, v143
    v_sub_f32 v32, v104, v172
    v_sub_f32 v33, v105, v172
    v_sub_f32 v34, v106, v172
    v_sub_f32 v35, v107, v172
    v_mul_f32 v32, v32, v173
    v_mul_f32 v33, v33, v173
    v_mul_f32 v34, v34, v173
    v_mul_f32 v35, v35, v173
    v_fmac_f32 v104, v32, v28
    v_fmac_f32 v105, v33, v29
    v_fmac_f32 v106, v34, v30
    v_fmac_f32 v107, v35, v31
    s_waitcnt vmcnt(9)
    v_lshlrev_b32 v28, 16, v162
    v_and_b32 v29, s81, v162
    v_lshlrev_b32 v30, 16, v163
    v_and_b32 v31, s81, v163
    v_lshlrev_b32 v108, 16, v144
    v_and_b32 v109, s81, v144
    v_lshlrev_b32 v110, 16, v145
    v_and_b32 v111, s81, v145
    v_sub_f32 v32, v108, v174
    v_sub_f32 v33, v109, v174
    v_sub_f32 v34, v110, v174
    v_sub_f32 v35, v111, v174
    v_mul_f32 v32, v32, v175
    v_mul_f32 v33, v33, v175
    v_mul_f32 v34, v34, v175
    v_mul_f32 v35, v35, v175
    v_fmac_f32 v108, v32, v28
    v_fmac_f32 v109, v33, v29
    v_fmac_f32 v110, v34, v30
    v_fmac_f32 v111, v35, v31
    v_lshlrev_b32 v112, 16, v146
    v_and_b32 v113, s81, v146
    v_lshlrev_b32 v114, 16, v147
    v_and_b32 v115, s81, v147
    v_sub_f32 v32, v112, v176
    v_sub_f32 v33, v113, v176
    v_sub_f32 v34, v114, v176
    v_sub_f32 v35, v115, v176
    v_mul_f32 v32, v32, v177
    v_mul_f32 v33, v33, v177
    v_mul_f32 v34, v34, v177
    v_mul_f32 v35, v35, v177
    v_fmac_f32 v112, v32, v28
    v_fmac_f32 v113, v33, v29
    v_fmac_f32 v114, v34, v30
    v_fmac_f32 v115, v35, v31
    s_waitcnt vmcnt(0)
    buffer_load_dword v11, v10, s[56:59], s76 offen sc1
    s_mov_b32 s99, 0
    v_lshlrev_b32 v28, 16, v164
    v_and_b32 v29, s81, v164
    v_lshlrev_b32 v30, 16, v165
    v_and_b32 v31, s81, v165
    v_lshlrev_b32 v116, 16, v148
    v_and_b32 v117, s81, v148
    v_lshlrev_b32 v118, 16, v149
    v_and_b32 v119, s81, v149
    v_sub_f32 v32, v116, v178
    v_sub_f32 v33, v117, v178
    v_sub_f32 v34, v118, v178
    v_sub_f32 v35, v119, v178
    v_mul_f32 v32, v32, v179
    v_mul_f32 v33, v33, v179
    v_mul_f32 v34, v34, v179
    v_mul_f32 v35, v35, v179
    v_fmac_f32 v116, v32, v28
    v_fmac_f32 v117, v33, v29
    v_fmac_f32 v118, v34, v30
    v_fmac_f32 v119, v35, v31
    v_lshlrev_b32 v120, 16, v150
    v_and_b32 v121, s81, v150
    v_lshlrev_b32 v122, 16, v151
    v_and_b32 v123, s81, v151
    v_sub_f32 v32, v120, v180
    v_sub_f32 v33, v121, v180
    v_sub_f32 v34, v122, v180
    v_sub_f32 v35, v123, v180
    v_mul_f32 v32, v32, v181
    v_mul_f32 v33, v33, v181
    v_mul_f32 v34, v34, v181
    v_mul_f32 v35, v35, v181
    v_fmac_f32 v120, v32, v28
    v_fmac_f32 v121, v33, v29
    v_fmac_f32 v122, v34, v30
    v_fmac_f32 v123, v35, v31
    v_lshlrev_b32 v28, 16, v166
    v_and_b32 v29, s81, v166
    v_lshlrev_b32 v30, 16, v167
    v_and_b32 v31, s81, v167
    v_lshlrev_b32 v124, 16, v152
    v_and_b32 v125, s81, v152
    v_lshlrev_b32 v126, 16, v153
    v_and_b32 v127, s81, v153
    v_sub_f32 v32, v124, v182
    v_sub_f32 v33, v125, v182
    v_sub_f32 v34, v126, v182
    v_sub_f32 v35, v127, v182
    v_mul_f32 v32, v32, v183
    v_mul_f32 v33, v33, v183
    v_mul_f32 v34, v34, v183
    v_mul_f32 v35, v35, v183
    v_fmac_f32 v124, v32, v28
    v_fmac_f32 v125, v33, v29
    v_fmac_f32 v126, v34, v30
    v_fmac_f32 v127, v35, v31
    v_lshlrev_b32 v128, 16, v154
    v_and_b32 v129, s81, v154
    v_lshlrev_b32 v130, 16, v155
    v_and_b32 v131, s81, v155
    v_sub_f32 v32, v128, v184
    v_sub_f32 v33, v129, v184
    v_sub_f32 v34, v130, v184
    v_sub_f32 v35, v131, v184
    v_mul_f32 v32, v32, v185
    v_mul_f32 v33, v33, v185
    v_mul_f32 v34, v34, v185
    v_mul_f32 v35, v35, v185
    v_fmac_f32 v128, v32, v28
    v_fmac_f32 v129, v33, v29
    v_fmac_f32 v130, v34, v30
    v_fmac_f32 v131, v35, v31
    s_waitcnt vmcnt(0)
    v_cmp_ne_u32 vcc, 1, v11
    s_cbranch_vccnz K_px_81
    s_mov_b32 s99, 1
    s_add_u32 m0, s17, 81920
    s_nop 0
    buffer_load_dwordx4 v7, s[56:59], s18 offen offset:0 sc1 lds
    buffer_load_dwordx4 v7, s[56:59], s18 offen offset:1024 sc1 lds
    buffer_load_dwordx4 v7, s[56:59], s18 offen offset:2048 sc1 lds
    buffer_load_dwordx4 v7, s[56:59], s18 offen offset:3072 sc1 lds
    s_add_u32 m0, s17, 86016
    s_nop 0
    buffer_load_dwordx4 v7, s[56:59], s74 offen sc1 lds
    s_branch K_px_81y
K_px_81:
    buffer_load_dword v11, v10, s[56:59], s76 offen sc1
K_px_81y:
    v_lshlrev_b32 v28, 16, v168
    v_and_b32 v29, s81, v168
    v_lshlrev_b32 v30, 16, v169
    v_and_b32 v31, s81, v169
    v_lshlrev_b32 v132, 16, v156
    v_and_b32 v133, s81, v156
    v_lshlrev_b32 v134, 16, v157
    v_and_b32 v135, s81, v157
    v_sub_f32 v32, v132, v186
    v_sub_f32 v33, v133, v186
    v_sub_f32 v34, v134, v186
    v_sub_f32 v35, v135, v186
    v_mul_f32 v32, v32, v187
    v_mul_f32 v33, v33, v187
    v_mul_f32 v34, v34, v187
    v_mul_f32 v35, v35, v187
    v_fmac_f32 v132, v32, v28
    v_fmac_f32 v133, v33, v29
    v_fmac_f32 v134, v34, v30
    v_fmac_f32 v135, v35, v31
    v_lshlrev_b32 v136, 16, v158
    v_and_b32 v137, s81, v158
    v_lshlrev_b32 v138, 16, v159
    v_and_b32 v139, s81, v159
    v_sub_f32 v32, v136, v188
    v_sub_f32 v33, v137, v188
    v_sub_f32 v34, v138, v188
    v_sub_f32 v35, v139, v188
    v_mul_f32 v32, v32, v189
    v_mul_f32 v33, v33, v189
    v_mul_f32 v34, v34, v189
    v_mul_f32 v35, v35, v189
    v_fmac_f32 v136, v32, v28
    v_fmac_f32 v137, v33, v29
    v_fmac_f32 v138, v34, v30
    v_fmac_f32 v139, v35, v31
    s_cmp_eq_u32 s99, 1
    s_cbranch_scc1 K_ppok_83z
K_pp_82:
    s_waitcnt vmcnt(0)
    v_cmp_ne_u32 vcc, 1, v11
    s_cbranch_vccz K_ppok_83
    s_sleep 2
    buffer_load_dword v11, v10, s[56:59], s76 offen sc1
    s_sub_u32 s80, s80, 1
    s_cmp_lg_u32 s80, 0
    s_cbranch_scc1 K_pp_82
K_ppok_83:
    s_add_u32 m0, s17, 81920
    s_nop 0
    buffer_load_dwordx4 v7, s[56:59], s18 offen offset:0 sc1 lds
    buffer_load_dwordx4 v7, s[56:59], s18 offen offset:1024 sc1 lds
    buffer_load_dwordx4 v7, s[56:59], s18 offen offset:2048 sc1 lds
    buffer_load_dwordx4 v7, s[56:59], s18 offen offset:3072 sc1 lds
    s_add_u32 m0, s17, 86016
    s_nop 0
    buffer_load_dwordx4 v7, s[56:59], s74 offen sc1 lds
K_ppok_83z:
    s_setprio 3
    s_barrier
    ds_read_b128 v[60:63], v12
    ds_read_b128 v[68:71], v13
    ds_read_b128 v[76:79], v14
    ds_read_b128 v[84:87], v15
    ds_read_b128 v[92:95], v16
    s_waitcnt vmcnt(0)
    ds_read_b128 v[36:39], v190
    ds_read_b128 v[40:43], v191
    ds_read_b128 v[44:47], v192
    ds_read_b128 v[48:51], v193
    ds_read_b128 v[52:55], v194
    s_waitcnt lgkmcnt(4)
    v_lshlrev_b32 v28, 16, v36
    v_and_b32 v29, s81, v36
    v_lshlrev_b32 v30, 16, v37
    v_and_b32 v31, s81, v37
    v_pk_add_f32 v[100:101], v[100:101], v[28:29]
    v_pk_add_f32 v[102:103], v[102:103], v[30:31]
    v_pk_add_f32 v[60:61], v[60:61], v[100:101]
    v_pk_add_f32 v[62:63], v[62:63], v[102:103]
    buffer_store_dwordx4 v[60:63], v195, s[12:15], s85 offen sc1 nt
    s_waitcnt lgkmcnt(3)
    v_lshlrev_b32 v28, 16, v40
    v_and_b32 v29, s81, v40
    v_lshlrev_b32 v30, 16, v41
    v_and_b32 v31, s81, v41
    v_pk_add_f32 v[108:109], v[108:109], v[28:29]
    v_pk_add_f32 v[110:111], v[110:111], v[30:31]
    v_pk_add_f32 v[68:69], v[68:69], v[108:109]
    v_pk_add_f32 v[70:71], v[70:71], v[110:111]
    buffer_store_dwordx4 v[68:71], v196, s[12:15], s85 offen sc1 nt
    s_waitcnt lgkmcnt(2)
    v_lshlrev_b32 v28, 16, v44
    v_and_b32 v29, s81, v44
    v_lshlrev_b32 v30, 16, v45
    v_and_b32 v31, s81, v45
    v_pk_add_f32 v[116:117], v[116:117], v[28:29]
    v_pk_add_f32 v[118:119], v[118:119], v[30:31]
    v_pk_add_f32 v[76:77], v[76:77], v[116:117]
    v_pk_add_f32 v[78:79], v[78:79], v[118:119]
    buffer_store_dwordx4 v[76:79], v197, s[12:15], s85 offen sc1 nt
    s_waitcnt lgkmcnt(1)
    v_lshlrev_b32 v28, 16, v48
    v_and_b32 v29, s81, v48
    v_lshlrev_b32 v30, 16, v49
    v_and_b32 v31, s81, v49
    v_pk_add_f32 v[124:125], v[124:125], v[28:29]
    v_pk_add_f32 v[126:127], v[126:127], v[30:31]
    v_pk_add_f32 v[84:85], v[84:85], v[124:125]
    v_pk_add_f32 v[86:87], v[86:87], v[126:127]
    buffer_store_dwordx4 v[84:87], v198, s[12:15], s85 offen sc1 nt
    s_waitcnt lgkmcnt(0)
    v_lshlrev_b32 v28, 16, v52
    v_and_b32 v29, s81, v52
    v_lshlrev_b32 v30, 16, v53
    v_and_b32 v31, s81, v53
    v_pk_add_f32 v[132:133], v[132:133], v[28:29]
    v_pk_add_f32 v[134:135], v[134:135], v[30:31]
    v_pk_add_f32 v[92:93], v[92:93], v[132:133]
    v_pk_add_f32 v[94:95], v[94:95], v[134:135]
    buffer_store_dwordx4 v[92:95], v199, s[12:15], s85 offen sc1 nt
    s_barrier
    ds_read_b128 v[64:67], v12 offset:5120
    ds_read_b128 v[72:75], v13 offset:5120
    ds_read_b128 v[80:83], v14 offset:5120
    ds_read_b128 v[88:91], v15 offset:5120
    ds_read_b128 v[96:99], v16 offset:5120
    v_lshlrev_b32 v28, 16, v38
    v_and_b32 v29, s81, v38
    v_lshlrev_b32 v30, 16, v39
    v_and_b32 v31, s81, v39
    v_pk_add_f32 v[104:105], v[104:105], v[28:29]
    v_pk_add_f32 v[106:107], v[106:107], v[30:31]
    s_waitcnt lgkmcnt(4)
    v_pk_add_f32 v[64:65], v[64:65], v[104:105]
    v_pk_add_f32 v[66:67], v[66:67], v[106:107]
    buffer_store_dwordx4 v[64:67], v195, s[12:15], s83 offen sc1 nt
    v_lshlrev_b32 v28, 16, v42
    v_and_b32 v29, s81, v42
    v_lshlrev_b32 v30, 16, v43
    v_and_b32 v31, s81, v43
    v_pk_add_f32 v[112:113], v[112:113], v[28:29]
    v_pk_add_f32 v[114:115], v[114:115], v[30:31]
    s_waitcnt lgkmcnt(3)
    v_pk_add_f32 v[72:73], v[72:73], v[112:113]
    v_pk_add_f32 v[74:75], v[74:75], v[114:115]
    buffer_store_dwordx4 v[72:75], v196, s[12:15], s83 offen sc1 nt
    v_lshlrev_b32 v28, 16, v46
    v_and_b32 v29, s81, v46
    v_lshlrev_b32 v30, 16, v47
    v_and_b32 v31, s81, v47
    v_pk_add_f32 v[120:121], v[120:121], v[28:29]
    v_pk_add_f32 v[122:123], v[122:123], v[30:31]
    s_waitcnt lgkmcnt(2)
    v_pk_add_f32 v[80:81], v[80:81], v[120:121]
    v_pk_add_f32 v[82:83], v[82:83], v[122:123]
    buffer_store_dwordx4 v[80:83], v197, s[12:15], s83 offen sc1 nt
    v_lshlrev_b32 v28, 16, v50
    v_and_b32 v29, s81, v50
    v_lshlrev_b32 v30, 16, v51
    v_and_b32 v31, s81, v51
    v_pk_add_f32 v[128:129], v[128:129], v[28:29]
    v_pk_add_f32 v[130:131], v[130:131], v[30:31]
    s_waitcnt lgkmcnt(1)
    v_pk_add_f32 v[88:89], v[88:89], v[128:129]
    v_pk_add_f32 v[90:91], v[90:91], v[130:131]
    buffer_store_dwordx4 v[88:91], v198, s[12:15], s83 offen sc1 nt
    v_lshlrev_b32 v28, 16, v54
    v_and_b32 v29, s81, v54
    v_lshlrev_b32 v30, 16, v55
    v_and_b32 v31, s81, v55
    v_pk_add_f32 v[136:137], v[136:137], v[28:29]
    v_pk_add_f32 v[138:139], v[138:139], v[30:31]
    s_waitcnt lgkmcnt(0)
    v_pk_add_f32 v[96:97], v[96:97], v[136:137]
    v_pk_add_f32 v[98:99], v[98:99], v[138:139]
    buffer_store_dwordx4 v[96:99], v199, s[12:15], s83 offen sc1 nt
K_fin:
K_done:
    s_endpgm
K_end:
.section .rodata,"a"
.p2align 6
.amdhsa_kernel parallel_sum__ssm_conv_s5__dense_activation_mish__prompt_kernel
  .amdhsa_next_free_vgpr 256
  .amdhsa_next_free_sgpr 102
  .amdhsa_accum_offset 256
  .amdhsa_group_segment_fixed_size 0
  .amdhsa_kernarg_size 128
  .amdhsa_user_sgpr_count 2
  .amdhsa_user_sgpr_kernarg_segment_ptr 1
  .amdhsa_system_sgpr_workgroup_id_x 1
  .amdhsa_float_denorm_mode_32 3
  .amdhsa_float_denorm_mode_16_64 3
.end_amdhsa_kernel
```
